```python
import torch

def _softmax(x, axis=-1):
    return torch.softmax(x, dim=axis)
def _gelu(x):
    return torch.nn.functional.gelu(x, approximate="tanh")
def _silu(x):
    return torch.nn.functional.silu(x)
def _sigmoid(x):
    return torch.sigmoid(x)
def _layernorm(x, axis=-1, eps=1e-5):
    m = x.mean(dim=axis, keepdim=True)
    v = x.var(dim=axis, keepdim=True, unbiased=False)
    return (x - m) / torch.sqrt(v + eps)
def _scatter_add(tgt, idx, src, axis=0):
    return tgt.clone().index_add_(axis, idx, src)
def _segment_sum(src, seg, n):
    out = torch.zeros((n,) + src.shape[1:], dtype=src.dtype)
    return out.index_add_(0, seg, src)
def _pad(x, pw):
    flat = tuple(v for pair in reversed(pw) for v in pair)
    return torch.nn.functional.pad(x, flat)

kernel_name = 'interleave_layers__sliding_block__mixer_channel_mlp__prompt'

def setup_inputs():

    _w = (lambda a: (lambda t: t.to(torch.bfloat16) if t.is_floating_point() else t)(torch.as_tensor(a)))
    def _A_setup():
        B, S, D = 1, 2048, 512
        return {
            "x": _w((lambda *s: torch.randn(*s, dtype=torch.bfloat16) * 0.05)(B, S, D)),
            "wqkv": _w((lambda *s: torch.randn(*s, dtype=torch.bfloat16) * 0.05)(D, 3 * D)),
            "wo": _w((lambda *s: torch.randn(*s, dtype=torch.bfloat16) * 0.05)(D, D)),
        }
    _A_in = _A_setup()

    def _B_setup():
        B, S, D, F = 1, 2048, 512, 1376
        return {
            "x": _w((lambda *s: torch.randn(*s, dtype=torch.bfloat16) * 0.05)(B, S, D)),
            "w1": _w((lambda *s: torch.randn(*s, dtype=torch.bfloat16) * 3.2)(D, F) * (D ** -0.5)),
            "b1": _w((lambda *s: torch.randn(*s, dtype=torch.bfloat16) * 0.8)(F)),
            "w2": _w((lambda *s: torch.randn(*s, dtype=torch.bfloat16) * 0.2)(F, D) * (F ** -0.5)),
            "b2": _w((lambda *s: torch.randn(*s, dtype=torch.bfloat16) * 0.2)(D)),
        }
    _B_in = _B_setup()

    return {
        "A_x": _A_in["x"],
        "A_wqkv": _A_in["wqkv"],
        "A_wo": _A_in["wo"],
        "B_x": _B_in["x"],
        "B_w1": _B_in["w1"],
        "B_b1": _B_in["b1"],
        "B_w2": _B_in["w2"],
        "B_b2": _B_in["b2"],
    }

def reference(A_x, A_wqkv, A_wo, B_x, B_w1, B_b1, B_w2, B_b2):
    def _A_ref(x, wqkv, wo):
        B, S, D = x.shape
        H = 32; Dh = D // H; W = 256
        qkv = (lambda x, *d: x.permute(*d))((x @ wqkv).reshape(B, S, 3, H, Dh), 2, 0, 3, 1, 4)
        q, k, v = qkv[0], qkv[1], qkv[2]
        scores = torch.einsum("bhqd,bhkd->bhqk", q, k) * (Dh ** -0.5)
        idx = torch.arange(S)
        mask = (idx[:, None] - idx[None, :] >= 0) & (idx[:, None] - idx[None, :] < W)
        scores = torch.where(mask[None, None], scores, -1e9)
        p = _softmax(scores, axis=-1)
        o = torch.einsum("bhqk,bhkd->bhqd", p, v)
        return (lambda x, *d: x.permute(*d))(o, 0, 2, 1, 3).reshape(B, S, D) @ wo

    def _B_ref(x, w1, b1, w2, b2):
        y = _layernorm(x, axis=-1)
        h = _gelu(torch.einsum("bsd,df->bsf", y, w1) + b1)
        return torch.einsum("bsf,fd->bsd", h, w2) + b2

    x = A_x
    x = x + _A_ref(_layernorm(x, axis=-1), A_wqkv, A_wo)
    x = x + _B_ref(_layernorm(x, axis=-1), B_w1, B_b1, B_w2, B_b2)
    x = x + _A_ref(_layernorm(x, axis=-1), A_wqkv, A_wo)
    x = x + _B_ref(_layernorm(x, axis=-1), B_w1, B_b1, B_w2, B_b2)
    return x
```

```asm
; @launch grid=(256,1,1) block=(512,1,1) lds=163840
.amdgcn_target "amdgcn-amd-amdhsa--gfx950"
.text
.globl interleave_layers__sliding_block__mixer_channel_mlp__prompt_kernel
.p2align 8
.type interleave_layers__sliding_block__mixer_channel_mlp__prompt_kernel,@function
interleave_layers__sliding_block__mixer_channel_mlp__prompt_kernel:
L_begin:
  s_cmp_ge_u32 s2, 256
  s_cbranch_scc1 L_exit
  s_load_dwordx16 s[52:67], s[0:1], 0
  s_load_dwordx4 s[68:71], s[0:1], 64
  s_load_dwordx2 s[72:73], s[0:1], 80
  s_and_b32 s40, s2, 7
  s_lshr_b32 s41, s2, 3
  v_lshrrev_b32 v8, 6, v0
  v_and_b32 v1, 63, v0
  v_readfirstlane_b32 s42, v8
  v_lshlrev_b32 v2, 4, v1
  v_lshlrev_b32 v3, 2, v1
  v_lshrrev_b32 v8, 5, v1
  v_lshlrev_b32 v5, 4, v8
  v_bfe_u32 v9, v1, 2, 2
  v_lshl_add_u32 v9, v8, 2, v9
  v_bfe_u32 v10, v1, 4, 1
  v_and_b32 v11, 3, v1
  v_lshlrev_b32 v11, 3, v11
  v_lshl_add_u32 v11, v10, 5, v11
  v_lshl_add_u32 v4, v9, 6, v11
  v_lshl_add_u32 v6, v9, 7, v11
  v_bfe_u32 v10, v1, 3, 1
  v_lshl_add_u32 v6, v10, 6, v6
  s_mov_b32 s46, 0
  s_mov_b32 s47, 0
  s_mov_b32 s45, 0
  s_mov_b32 s100, 0x409d30fc
  s_mov_b32 s101, 0x409d30fc
  s_mov_b32 s80, 0xbeeff558
  s_mov_b32 s81, 0xbeeff558
  s_waitcnt lgkmcnt(0)
  s_lshl_b32 s74, s40, 8
  s_add_u32 s74, s74, 18874368
  s_sub_u32 s75, s74, 256
  s_cmp_eq_u32 s40, 0
  s_cselect_b32 s75, s74, s75
  s_cmp_lg_u32 s42, 4
  s_cbranch_scc1 Lep_1
  s_load_dword s76, s[72:73], s74
  s_load_dword s77, s[72:73], s75
Lep_1:
  s_mov_b32 s4, s52
  s_and_b32 s5, s53, 0xffff
  s_mov_b32 s6, 2097152
  s_mov_b32 s7, 0x20000
  s_mov_b32 s8, s54
  s_and_b32 s9, s55, 0xffff
  s_mov_b32 s10, 1572864
  s_mov_b32 s11, 0x20000
  s_mov_b32 s12, s56
  s_and_b32 s13, s57, 0xffff
  s_mov_b32 s14, 524288
  s_mov_b32 s15, 0x20000
  s_mov_b32 s16, s60
  s_and_b32 s17, s61, 0xffff
  s_mov_b32 s18, 1409024
  s_mov_b32 s19, 0x20000
  s_mov_b32 s32, s62
  s_and_b32 s33, s63, 0xffff
  s_mov_b32 s34, 2752
  s_mov_b32 s35, 0x20000
  s_mov_b32 s20, s64
  s_and_b32 s21, s65, 0xffff
  s_mov_b32 s22, 1409024
  s_mov_b32 s23, 0x20000
  s_mov_b32 s36, s66
  s_and_b32 s37, s67, 0xffff
  s_mov_b32 s38, 1024
  s_mov_b32 s39, 0x20000
  s_mov_b32 s28, s68
  s_and_b32 s29, s69, 0xffff
  s_mov_b32 s30, 2097152
  s_mov_b32 s31, 0x20000
  s_mov_b32 s24, s72
  s_and_b32 s25, s73, 0xffff
  s_mov_b32 s26, 18911232
  s_mov_b32 s27, 0x20000
  s_cmp_ge_u32 s42, 4
  s_cbranch_scc1 L_help0
  s_lshr_b32 s50, s41, 2
  s_lshl_b32 s82, s40, 3
  s_add_u32 s82, s82, s50
  s_and_b32 s52, s41, 3
  s_lshl_b32 s52, s52, 2
  s_add_u32 s52, s52, s42
  s_lshl_b32 s53, s82, 15
  s_lshl_b32 s83, s52, 6
  s_add_u32 s53, s53, s83
  v_and_b32 v8, 31, v1
  v_lshlrev_b32 v8, 10, v8
  v_lshrrev_b32 v9, 1, v5
  v_add_u32 v8, v8, v9
  buffer_load_dwordx2 v[16:17], v8, s[4:7], s53 offen offset:0
  buffer_load_dwordx2 v[18:19], v8, s[4:7], s53 offen offset:16
  buffer_load_dwordx2 v[20:21], v8, s[4:7], s53 offen offset:32
  buffer_load_dwordx2 v[22:23], v8, s[4:7], s53 offen offset:48
  s_lshl_b32 s55, s82, 15
  s_lshl_b32 s83, s52, 11
  s_add_u32 s55, s55, s83
  s_lshr_b32 s58, s52, 2
  s_and_b32 s59, s52, 3
  s_lshl_b32 s56, s82, 12
  s_lshl_b32 s83, s58, 10
  s_add_u32 s56, s56, s83
  s_lshl_b32 s83, s59, 2
  s_add_u32 s56, s56, s83
  s_add_u32 s56, s56, 8388608
  s_lshl_b32 s57, s82, 11
  s_lshl_b32 s83, s52, 7
  s_add_u32 s57, s57, s83
  s_add_u32 s57, s57, 13631488
  s_waitcnt vmcnt(0)
  v_mov_b32 v10, 0
  v_mov_b32 v11, 0
  v_lshlrev_b32 v12, 16, v16
  v_and_b32 v13, 0xffff0000, v16
  v_add_f32 v10, v10, v12
  v_fmac_f32 v11, v12, v12
  v_add_f32 v10, v10, v13
  v_fmac_f32 v11, v13, v13
  v_lshlrev_b32 v12, 16, v17
  v_and_b32 v13, 0xffff0000, v17
  v_add_f32 v10, v10, v12
  v_fmac_f32 v11, v12, v12
  v_add_f32 v10, v10, v13
  v_fmac_f32 v11, v13, v13
  v_lshlrev_b32 v12, 16, v18
  v_and_b32 v13, 0xffff0000, v18
  v_add_f32 v10, v10, v12
  v_fmac_f32 v11, v12, v12
  v_add_f32 v10, v10, v13
  v_fmac_f32 v11, v13, v13
  v_lshlrev_b32 v12, 16, v19
  v_and_b32 v13, 0xffff0000, v19
  v_add_f32 v10, v10, v12
  v_fmac_f32 v11, v12, v12
  v_add_f32 v10, v10, v13
  v_fmac_f32 v11, v13, v13
  v_lshlrev_b32 v12, 16, v20
  v_and_b32 v13, 0xffff0000, v20
  v_add_f32 v10, v10, v12
  v_fmac_f32 v11, v12, v12
  v_add_f32 v10, v10, v13
  v_fmac_f32 v11, v13, v13
  v_lshlrev_b32 v12, 16, v21
  v_and_b32 v13, 0xffff0000, v21
  v_add_f32 v10, v10, v12
  v_fmac_f32 v11, v12, v12
  v_add_f32 v10, v10, v13
  v_fmac_f32 v11, v13, v13
  v_lshlrev_b32 v12, 16, v22
  v_and_b32 v13, 0xffff0000, v22
  v_add_f32 v10, v10, v12
  v_fmac_f32 v11, v12, v12
  v_add_f32 v10, v10, v13
  v_fmac_f32 v11, v13, v13
  v_lshlrev_b32 v12, 16, v23
  v_and_b32 v13, 0xffff0000, v23
  v_add_f32 v10, v10, v12
  v_fmac_f32 v11, v12, v12
  v_add_f32 v10, v10, v13
  v_fmac_f32 v11, v13, v13
  s_nop 1
  v_permlane32_swap_b32 v10, v11
  v_add_f32 v10, v10, v11
  s_barrier
  v_mov_b32 v14, 163824
  ds_read_b64 v[14:15], v14
  s_waitcnt lgkmcnt(0)
  v_readfirstlane_b32 s43, v14
  v_readfirstlane_b32 s44, v15
  v_mov_b32 v14, 163832
  ds_read_b32 v14, v14
  s_waitcnt lgkmcnt(0)
  v_readfirstlane_b32 s45, v14
  s_nop 0
  s_cmp_eq_u32 s45, 0
  s_cbranch_scc1 Lgs_2
  buffer_store_dwordx4 v[16:19], v2, s[24:27], s55 offen
  buffer_store_dwordx4 v[20:23], v2, s[24:27], s55 offen offset:1024
  buffer_store_dword v10, v2, s[24:27], s56 offen
  s_branch Lgsd_3
Lgs_2:
  buffer_store_dwordx4 v[16:19], v2, s[24:27], s55 offen sc1
  buffer_store_dwordx4 v[20:23], v2, s[24:27], s55 offen offset:1024 sc1
  buffer_store_dword v10, v2, s[24:27], s56 offen sc1
Lgsd_3:
  s_waitcnt vmcnt(0)
  s_mov_b64 exec, 1
  v_mov_b32 v14, s43
  v_mov_b32 v15, 0
  s_cmp_eq_u32 s45, 0
  s_cbranch_scc1 Lgs_4
  buffer_store_dword v14, v15, s[24:27], s57 offen
  s_branch Lgsd_5
Lgs_4:
  buffer_store_dword v14, v15, s[24:27], s57 offen sc1
Lgsd_5:
  s_mov_b64 exec, -1
  s_barrier
  s_branch L_layer0
L_help0:
  s_cmp_lg_u32 s42, 4
  s_cbranch_scc1 L_help5
  s_waitcnt lgkmcnt(0)
  s_add_u32 s43, s76, 1
  s_add_u32 s44, s77, 1
  s_getreg_b32 s50, hwreg(HW_REG_XCC_ID, 0, 4)
  s_and_b32 s51, s43, 0x0fffffff
  s_lshl_b32 s52, s50, 28
  s_or_b32 s52, s52, s51
  s_lshl_b32 s53, s40, 12
  s_add_u32 s53, s53, 18878464
  s_lshl_b32 s54, s41, 7
  s_add_u32 s54, s54, s53
  s_mov_b64 exec, 1
  v_mov_b32 v14, s52
  v_mov_b32 v15, 0
  buffer_store_dword v14, v15, s[24:27], s54 offen sc1
  s_mov_b64 exec, -1
  v_and_b32 v12, 31, v1
  v_lshlrev_b32 v12, 7, v12
  s_mov_b32 s79, 262144
Lcen_6:
  buffer_load_dword v13, v12, s[24:27], s53 offen sc1
  s_sub_u32 s79, s79, 1
  s_cbranch_scc1 Lcend_7
  s_waitcnt vmcnt(0)
  v_and_b32 v14, 0x0fffffff, v13
  v_cmp_ne_u32 vcc, s51, v14
  s_cbranch_vccnz Lcen_6
Lcend_7:
  s_waitcnt vmcnt(0)
  v_cmp_ne_u32 vcc, s52, v13
  s_nop 0
  s_cmp_eq_u64 vcc, 0
  s_cselect_b32 s55, 1, 0
  v_mov_b32 v14, s55
  v_mov_b32 v15, 163832
  ds_write_b32 v15, v14
  v_mov_b32 v14, 0
  ds_write_b32 v15, v14 offset:4
  v_mov_b32 v12, s43
  v_mov_b32 v13, s44
  v_mov_b32 v15, 163824
  ds_write_b64 v15, v[12:13]
  s_waitcnt lgkmcnt(0)
  s_barrier
  s_barrier
  s_branch L_layer0
L_help5:
  s_sub_u32 s60, s42, 5
  s_lshr_b32 s70, s41, 1
  s_mul_i32 s71, s70, 3
  s_lshl_b32 s72, s70, 1
  s_add_u32 s72, s72, 11
  s_cmp_lt_u32 s70, 11
  s_cselect_b32 s61, s71, s72
  s_add_u32 s61, s61, s60
  s_min_u32 s61, s61, 42
  s_lshl_b32 s61, s61, 6
  v_and_b32 v12, 31, v1
  v_lshlrev_b32 v12, 1, v12
  buffer_load_ushort v247, v12, s[32:35], s61 offen
  s_cmp_eq_u32 s42, 5
  s_cbranch_scc0 Lta_10
  s_getpc_b64 s[90:91]
L_pc0:
  s_sub_u32 s90, s90, L_pc0-L_begin
  s_subb_u32 s91, s91, 0
  s_mov_b32 s92, (L_exit-L_begin+4095)/4096*128
  s_mul_i32 s93, s92, s41
  v_lshlrev_b32 v246, 7, v1
  s_sub_u32 s92, s92, 128
  v_min_u32 v246, s92, v246
  v_add_u32 v246, s93, v246
  s_mov_b32 s92, L_exit-L_begin
  v_min_u32 v246, s92, v246
  global_load_dword v245, v246, s[90:91]
  v_lshlrev_b32 v244, 7, v1
  v_min_u32 v244, 1920, v244
  s_mul_i32 s83, s2, 2048
  buffer_load_dword v243, v244, s[12:15], s83 offen
Lta_10:
  s_cmp_eq_u32 s42, 6
  s_cbranch_scc0 Ltb_11
  v_lshlrev_b32 v244, 7, v1
  v_min_u32 v244, 5376, v244
  s_mul_i32 s83, s2, 5504
  buffer_load_dword v243, v244, s[16:19], s83 offen
Ltb_11:
  s_lshr_b32 s50, s41, 1
  s_cmp_eq_u32 s42, 7
  s_cbranch_scc1 Lq7_8
  v_lshrrev_b32 v14, 3, v1
  v_mul_u32_u24 v14, 3072, v14
  v_bfe_u32 v15, v1, 4, 1
  v_lshlrev_b32 v15, 2, v15
  v_xor_b32 v15, v15, v1
  v_and_b32 v15, 7, v15
  v_lshl_add_u32 v8, v15, 4, v14
  s_and_b32 s51, s50, 1
  s_lshr_b32 s52, s50, 1
  s_sub_u32 s53, s42, 5
  s_mul_i32 s54, s53, 24576
  s_lshl_b32 s51, s51, 10
  s_lshl_b32 s83, s52, 7
  s_add_u32 s51, s51, s83
  s_add_u32 s51, s51, s54
  s_add_u32 s51, s51, 1024
  s_lshl_b32 s52, s53, 10
  s_add_u32 s52, s52, 32768
  s_and_b32 s53, s41, 1
  s_lshl_b32 s53, s53, 3
  s_barrier
  s_barrier
  s_mov_b32 s73, s53
  s_mul_i32 s74, s73, 49152
  s_mul_i32 s75, s73, 2048
  s_add_u32 s74, s74, s51
  s_add_u32 s75, s75, s52
  s_mov_b32 m0, s75
  s_add_u32 s73, s73, 1
  buffer_load_dwordx4 v8, s[8:11], s74 offen lds
  s_cmp_eq_u32 s73, 16
  s_cselect_b32 s73, 0, s73
  s_mul_i32 s74, s73, 49152
  s_mul_i32 s75, s73, 2048
  s_add_u32 s74, s74, s51
  s_add_u32 s75, s75, s52
  s_mov_b32 m0, s75
  s_add_u32 s73, s73, 1
  buffer_load_dwordx4 v8, s[8:11], s74 offen lds
  s_cmp_eq_u32 s73, 16
  s_cselect_b32 s73, 0, s73
  s_mul_i32 s74, s73, 49152
  s_mul_i32 s75, s73, 2048
  s_add_u32 s74, s74, s51
  s_add_u32 s75, s75, s52
  s_mov_b32 m0, s75
  s_add_u32 s73, s73, 1
  buffer_load_dwordx4 v8, s[8:11], s74 offen lds
  s_cmp_eq_u32 s73, 16
  s_cselect_b32 s73, 0, s73
  s_mul_i32 s74, s73, 49152
  s_mul_i32 s75, s73, 2048
  s_add_u32 s74, s74, s51
  s_add_u32 s75, s75, s52
  s_mov_b32 m0, s75
  s_add_u32 s73, s73, 1
  buffer_load_dwordx4 v8, s[8:11], s74 offen lds
  s_cmp_eq_u32 s73, 16
  s_cselect_b32 s73, 0, s73
  s_mul_i32 s74, s73, 49152
  s_mul_i32 s75, s73, 2048
  s_add_u32 s74, s74, s51
  s_add_u32 s75, s75, s52
  s_mov_b32 m0, s75
  s_add_u32 s73, s73, 1
  buffer_load_dwordx4 v8, s[8:11], s74 offen lds
  s_cmp_eq_u32 s73, 16
  s_cselect_b32 s73, 0, s73
  s_mul_i32 s74, s73, 49152
  s_mul_i32 s75, s73, 2048
  s_add_u32 s74, s74, s51
  s_add_u32 s75, s75, s52
  s_mov_b32 m0, s75
  s_add_u32 s73, s73, 1
  buffer_load_dwordx4 v8, s[8:11], s74 offen lds
  s_cmp_eq_u32 s73, 16
  s_cselect_b32 s73, 0, s73
  s_mul_i32 s74, s73, 49152
  s_mul_i32 s75, s73, 2048
  s_add_u32 s74, s74, s51
  s_add_u32 s75, s75, s52
  s_mov_b32 m0, s75
  s_add_u32 s73, s73, 1
  buffer_load_dwordx4 v8, s[8:11], s74 offen lds
  s_cmp_eq_u32 s73, 16
  s_cselect_b32 s73, 0, s73
  s_mul_i32 s74, s73, 49152
  s_mul_i32 s75, s73, 2048
  s_add_u32 s74, s74, s51
  s_add_u32 s75, s75, s52
  s_mov_b32 m0, s75
  s_add_u32 s73, s73, 1
  buffer_load_dwordx4 v8, s[8:11], s74 offen lds
  s_cmp_eq_u32 s73, 16
  s_cselect_b32 s73, 0, s73
  s_mul_i32 s74, s73, 49152
  s_mul_i32 s75, s73, 2048
  s_add_u32 s74, s74, s51
  s_add_u32 s75, s75, s52
  s_mov_b32 m0, s75
  s_add_u32 s73, s73, 1
  buffer_load_dwordx4 v8, s[8:11], s74 offen lds
  s_cmp_eq_u32 s73, 16
  s_cselect_b32 s73, 0, s73
  s_mul_i32 s74, s73, 49152
  s_mul_i32 s75, s73, 2048
  s_add_u32 s74, s74, s51
  s_add_u32 s75, s75, s52
  s_mov_b32 m0, s75
  s_add_u32 s73, s73, 1
  buffer_load_dwordx4 v8, s[8:11], s74 offen lds
  s_cmp_eq_u32 s73, 16
  s_cselect_b32 s73, 0, s73
  s_mul_i32 s74, s73, 49152
  s_mul_i32 s75, s73, 2048
  s_add_u32 s74, s74, s51
  s_add_u32 s75, s75, s52
  s_mov_b32 m0, s75
  s_add_u32 s73, s73, 1
  buffer_load_dwordx4 v8, s[8:11], s74 offen lds
  s_cmp_eq_u32 s73, 16
  s_cselect_b32 s73, 0, s73
  s_mul_i32 s74, s73, 49152
  s_mul_i32 s75, s73, 2048
  s_add_u32 s74, s74, s51
  s_add_u32 s75, s75, s52
  s_mov_b32 m0, s75
  s_add_u32 s73, s73, 1
  buffer_load_dwordx4 v8, s[8:11], s74 offen lds
  s_cmp_eq_u32 s73, 16
  s_cselect_b32 s73, 0, s73
  s_mul_i32 s74, s73, 49152
  s_mul_i32 s75, s73, 2048
  s_add_u32 s74, s74, s51
  s_add_u32 s75, s75, s52
  s_mov_b32 m0, s75
  s_add_u32 s73, s73, 1
  buffer_load_dwordx4 v8, s[8:11], s74 offen lds
  s_cmp_eq_u32 s73, 16
  s_cselect_b32 s73, 0, s73
  s_mul_i32 s74, s73, 49152
  s_mul_i32 s75, s73, 2048
  s_add_u32 s74, s74, s51
  s_add_u32 s75, s75, s52
  s_mov_b32 m0, s75
  s_add_u32 s73, s73, 1
  buffer_load_dwordx4 v8, s[8:11], s74 offen lds
  s_cmp_eq_u32 s73, 16
  s_cselect_b32 s73, 0, s73
  s_mul_i32 s74, s73, 49152
  s_mul_i32 s75, s73, 2048
  s_add_u32 s74, s74, s51
  s_add_u32 s75, s75, s52
  s_mov_b32 m0, s75
  s_add_u32 s73, s73, 1
  buffer_load_dwordx4 v8, s[8:11], s74 offen lds
  s_cmp_eq_u32 s73, 16
  s_cselect_b32 s73, 0, s73
  s_mul_i32 s74, s73, 49152
  s_mul_i32 s75, s73, 2048
  s_add_u32 s74, s74, s51
  s_add_u32 s75, s75, s52
  s_mov_b32 m0, s75
  s_add_u32 s73, s73, 1
  buffer_load_dwordx4 v8, s[8:11], s74 offen lds
  s_add_u32 s51, s51, 786432
  s_add_u32 s52, s52, 32768
  s_mov_b32 s73, s53
  s_mul_i32 s74, s73, 49152
  s_mul_i32 s75, s73, 2048
  s_add_u32 s74, s74, s51
  s_add_u32 s75, s75, s52
  s_mov_b32 m0, s75
  s_add_u32 s73, s73, 1
  buffer_load_dwordx4 v8, s[8:11], s74 offen lds
  s_cmp_eq_u32 s73, 16
  s_cselect_b32 s73, 0, s73
  s_mul_i32 s74, s73, 49152
  s_mul_i32 s75, s73, 2048
  s_add_u32 s74, s74, s51
  s_add_u32 s75, s75, s52
  s_mov_b32 m0, s75
  s_add_u32 s73, s73, 1
  buffer_load_dwordx4 v8, s[8:11], s74 offen lds
  s_cmp_eq_u32 s73, 16
  s_cselect_b32 s73, 0, s73
  s_mul_i32 s74, s73, 49152
  s_mul_i32 s75, s73, 2048
  s_add_u32 s74, s74, s51
  s_add_u32 s75, s75, s52
  s_mov_b32 m0, s75
  s_add_u32 s73, s73, 1
  buffer_load_dwordx4 v8, s[8:11], s74 offen lds
  s_cmp_eq_u32 s73, 16
  s_cselect_b32 s73, 0, s73
  s_mul_i32 s74, s73, 49152
  s_mul_i32 s75, s73, 2048
  s_add_u32 s74, s74, s51
  s_add_u32 s75, s75, s52
  s_mov_b32 m0, s75
  s_add_u32 s73, s73, 1
  buffer_load_dwordx4 v8, s[8:11], s74 offen lds
  s_cmp_eq_u32 s73, 16
  s_cselect_b32 s73, 0, s73
  s_mul_i32 s74, s73, 49152
  s_mul_i32 s75, s73, 2048
  s_add_u32 s74, s74, s51
  s_add_u32 s75, s75, s52
  s_mov_b32 m0, s75
  s_add_u32 s73, s73, 1
  buffer_load_dwordx4 v8, s[8:11], s74 offen lds
  s_cmp_eq_u32 s73, 16
  s_cselect_b32 s73, 0, s73
  s_mul_i32 s74, s73, 49152
  s_mul_i32 s75, s73, 2048
  s_add_u32 s74, s74, s51
  s_add_u32 s75, s75, s52
  s_mov_b32 m0, s75
  s_add_u32 s73, s73, 1
  buffer_load_dwordx4 v8, s[8:11], s74 offen lds
  s_cmp_eq_u32 s73, 16
  s_cselect_b32 s73, 0, s73
  s_mul_i32 s74, s73, 49152
  s_mul_i32 s75, s73, 2048
  s_add_u32 s74, s74, s51
  s_add_u32 s75, s75, s52
  s_mov_b32 m0, s75
  s_add_u32 s73, s73, 1
  buffer_load_dwordx4 v8, s[8:11], s74 offen lds
  s_cmp_eq_u32 s73, 16
  s_cselect_b32 s73, 0, s73
  s_mul_i32 s74, s73, 49152
  s_mul_i32 s75, s73, 2048
  s_add_u32 s74, s74, s51
  s_add_u32 s75, s75, s52
  s_mov_b32 m0, s75
  s_add_u32 s73, s73, 1
  buffer_load_dwordx4 v8, s[8:11], s74 offen lds
  s_cmp_eq_u32 s73, 16
  s_cselect_b32 s73, 0, s73
  s_mul_i32 s74, s73, 49152
  s_mul_i32 s75, s73, 2048
  s_add_u32 s74, s74, s51
  s_add_u32 s75, s75, s52
  s_mov_b32 m0, s75
  s_add_u32 s73, s73, 1
  buffer_load_dwordx4 v8, s[8:11], s74 offen lds
  s_cmp_eq_u32 s73, 16
  s_cselect_b32 s73, 0, s73
  s_mul_i32 s74, s73, 49152
  s_mul_i32 s75, s73, 2048
  s_add_u32 s74, s74, s51
  s_add_u32 s75, s75, s52
  s_mov_b32 m0, s75
  s_add_u32 s73, s73, 1
  buffer_load_dwordx4 v8, s[8:11], s74 offen lds
  s_cmp_eq_u32 s73, 16
  s_cselect_b32 s73, 0, s73
  s_mul_i32 s74, s73, 49152
  s_mul_i32 s75, s73, 2048
  s_add_u32 s74, s74, s51
  s_add_u32 s75, s75, s52
  s_mov_b32 m0, s75
  s_add_u32 s73, s73, 1
  buffer_load_dwordx4 v8, s[8:11], s74 offen lds
  s_cmp_eq_u32 s73, 16
  s_cselect_b32 s73, 0, s73
  s_mul_i32 s74, s73, 49152
  s_mul_i32 s75, s73, 2048
  s_add_u32 s74, s74, s51
  s_add_u32 s75, s75, s52
  s_mov_b32 m0, s75
  s_add_u32 s73, s73, 1
  buffer_load_dwordx4 v8, s[8:11], s74 offen lds
  s_cmp_eq_u32 s73, 16
  s_cselect_b32 s73, 0, s73
  s_mul_i32 s74, s73, 49152
  s_mul_i32 s75, s73, 2048
  s_add_u32 s74, s74, s51
  s_add_u32 s75, s75, s52
  s_mov_b32 m0, s75
  s_add_u32 s73, s73, 1
  buffer_load_dwordx4 v8, s[8:11], s74 offen lds
  s_cmp_eq_u32 s73, 16
  s_cselect_b32 s73, 0, s73
  s_mul_i32 s74, s73, 49152
  s_mul_i32 s75, s73, 2048
  s_add_u32 s74, s74, s51
  s_add_u32 s75, s75, s52
  s_mov_b32 m0, s75
  s_add_u32 s73, s73, 1
  buffer_load_dwordx4 v8, s[8:11], s74 offen lds
  s_cmp_eq_u32 s73, 16
  s_cselect_b32 s73, 0, s73
  s_mul_i32 s74, s73, 49152
  s_mul_i32 s75, s73, 2048
  s_add_u32 s74, s74, s51
  s_add_u32 s75, s75, s52
  s_mov_b32 m0, s75
  s_add_u32 s73, s73, 1
  buffer_load_dwordx4 v8, s[8:11], s74 offen lds
  s_cmp_eq_u32 s73, 16
  s_cselect_b32 s73, 0, s73
  s_mul_i32 s74, s73, 49152
  s_mul_i32 s75, s73, 2048
  s_add_u32 s74, s74, s51
  s_add_u32 s75, s75, s52
  s_mov_b32 m0, s75
  s_add_u32 s73, s73, 1
  buffer_load_dwordx4 v8, s[8:11], s74 offen lds
  s_branch Lq7d_9
Lq7_8:
  v_lshlrev_b32 v244, 7, v1
  v_min_u32 v244, 6016, v244
  s_mul_i32 s83, s2, 6144
  buffer_load_dword v243, v244, s[8:11], s83 offen
  s_barrier
  s_barrier
Lq7d_9:
  v_mov_b32 v14, 163824
  ds_read_b64 v[14:15], v14
  s_waitcnt lgkmcnt(0)
  v_readfirstlane_b32 s43, v14
  v_readfirstlane_b32 s44, v15
L_layer0:
  s_mov_b32 s4, 0x3f800000
  s_mov_b32 s5, 0x3f800000
  s_mov_b32 s6, 0xc0088e99
  s_mov_b32 s7, 0xc0088e99
L_layer:
  s_cmp_ge_u32 s42, 4
  s_cbranch_scc1 L_qkv_h
  s_and_b32 s50, s41, 1
  s_lshl_b32 s50, s50, 2
  s_add_u32 s50, s50, s42
  s_lshl_b32 s82, s40, 3
  s_add_u32 s82, s82, s50
  s_lshr_b32 s52, s41, 1
  s_lshl_b32 s53, s82, 11
  s_add_u32 s53, s53, s46
  s_add_u32 s53, s53, 13631488
  s_mul_i32 s55, s82, 98304
  s_add_u32 s55, s55, 2097152
  s_lshl_b32 s56, s82, 15
  s_lshl_b32 s57, s82, 12
  s_add_u32 s57, s57, 8388608
  v_add_u32 v10, 32768, v6
  v_xor_b32 v11, 64, v10
  v_add_u32 v13, 162816, v5
  s_and_b32 s58, s52, 1
  s_lshr_b32 s59, s52, 1
  s_lshl_b32 s59, s59, 12
  s_lshl_b32 s60, s82, 15
  s_lshl_b32 s83, s58, 21
  s_add_u32 s60, s60, s83
  s_add_u32 s60, s60, s59
  s_add_u32 s60, s60, s46
  s_add_u32 s60, s60, 9437184
  s_mov_b32 s59, s59
  s_lshl_b32 s83, s58, 15
  s_add_u32 s59, s59, s83
  s_add_u32 s59, s59, s55
  s_add_u32 s59, s59, 32768
  s_lshl_b32 s61, s52, 11
  s_add_u32 s61, s61, s55
  s_lshl_b32 s62, s40, 7
  s_lshl_b32 s83, s52, 3
  s_add_u32 s62, s62, s83
  s_add_u32 s62, s62, s50
  s_lshl_b32 s63, s62, 2
  s_add_u32 s63, s63, s46
  s_add_u32 s63, s63, 13893632
  s_mov_b32 s64, s63
  s_add_u32 s64, s64, 32768
  s_lshl_b32 s62, s62, 7
  s_add_u32 s62, s62, s46
  s_add_u32 s62, s62, 13762560
  v_and_b32 v14, 15, v1
  v_lshlrev_b32 v14, 7, v14
  s_mov_b32 s79, 262144
Lpoll_12:
  buffer_load_dword v15, v14, s[24:27], s53 offen sc1
  s_sub_u32 s79, s79, 1
  s_cbranch_scc1 Lpolld_13
  s_waitcnt vmcnt(0)
  v_cmp_ne_u32 vcc, s43, v15
  s_cbranch_vccnz Lpoll_12
Lpolld_13:
  s_waitcnt vmcnt(0)
  buffer_load_dwordx4 v[128:131], v2, s[24:27], s56 offen offset:0 sc1
  buffer_load_dwordx4 v[132:135], v2, s[24:27], s56 offen offset:1024 sc1
  buffer_load_dwordx4 v[136:139], v2, s[24:27], s56 offen offset:2048 sc1
  buffer_load_dwordx4 v[140:143], v2, s[24:27], s56 offen offset:3072 sc1
  s_add_u32 s56, s56, 4096
  buffer_load_dwordx4 v[144:147], v2, s[24:27], s56 offen offset:0 sc1
  buffer_load_dwordx4 v[148:151], v2, s[24:27], s56 offen offset:1024 sc1
  buffer_load_dwordx4 v[152:155], v2, s[24:27], s56 offen offset:2048 sc1
  buffer_load_dwordx4 v[156:159], v2, s[24:27], s56 offen offset:3072 sc1
  s_add_u32 s56, s56, 4096
  v_and_b32 v12, 31, v1
  v_lshl_add_u32 v12, v12, 5, v5
  s_cmp_eq_u32 s58, 1
  s_cselect_b64 vcc, -1, 0
  v_cndmask_b32 v12, v2, v12, vcc
  s_barrier
  v_mov_b32 v14, 163832
  ds_read_b32 v14, v14
  s_waitcnt lgkmcnt(0)
  v_readfirstlane_b32 s45, v14
  ds_read_b64_tr_b16 v[56:57], v10 offset:0
  ds_read_b64_tr_b16 v[58:59], v10 offset:1024
  ds_read_b64_tr_b16 v[60:61], v11 offset:0
  ds_read_b64_tr_b16 v[62:63], v11 offset:1024
  s_waitcnt vmcnt(7)
  s_waitcnt lgkmcnt(2)
  v_mfma_f32_32x32x16_bf16 v[96:111], v[56:59], v[128:131], 0
  ds_read_b64_tr_b16 v[64:65], v10 offset:2048
  ds_read_b64_tr_b16 v[66:67], v10 offset:3072
  buffer_load_dwordx4 v[160:163], v2, s[24:27], s56 offen offset:0 sc1
  s_waitcnt lgkmcnt(2)
  v_mfma_f32_32x32x16_bf16 v[112:127], v[60:63], v[128:131], 0
  ds_read_b64_tr_b16 v[68:69], v11 offset:2048
  ds_read_b64_tr_b16 v[70:71], v11 offset:3072
  s_waitcnt vmcnt(7)
  s_waitcnt lgkmcnt(2)
  v_mfma_f32_32x32x16_bf16 v[96:111], v[64:67], v[132:135], v[96:111]
  ds_read_b64_tr_b16 v[56:57], v10 offset:4096
  ds_read_b64_tr_b16 v[58:59], v10 offset:5120
  buffer_load_dwordx4 v[164:167], v2, s[24:27], s56 offen offset:1024 sc1
  s_waitcnt lgkmcnt(2)
  v_mfma_f32_32x32x16_bf16 v[112:127], v[68:71], v[132:135], v[112:127]
  ds_read_b64_tr_b16 v[60:61], v11 offset:4096
  ds_read_b64_tr_b16 v[62:63], v11 offset:5120
  s_waitcnt vmcnt(7)
  s_waitcnt lgkmcnt(2)
  v_mfma_f32_32x32x16_bf16 v[96:111], v[56:59], v[136:139], v[96:111]
  ds_read_b64_tr_b16 v[64:65], v10 offset:6144
  ds_read_b64_tr_b16 v[66:67], v10 offset:7168
  buffer_load_dwordx4 v[168:171], v2, s[24:27], s56 offen offset:2048 sc1
  s_waitcnt lgkmcnt(2)
  v_mfma_f32_32x32x16_bf16 v[112:127], v[60:63], v[136:139], v[112:127]
  ds_read_b64_tr_b16 v[68:69], v11 offset:6144
  ds_read_b64_tr_b16 v[70:71], v11 offset:7168
  s_waitcnt vmcnt(7)
  s_waitcnt lgkmcnt(2)
  v_mfma_f32_32x32x16_bf16 v[96:111], v[64:67], v[140:143], v[96:111]
  ds_read_b64_tr_b16 v[56:57], v10 offset:8192
  ds_read_b64_tr_b16 v[58:59], v10 offset:9216
  buffer_load_dwordx4 v[172:175], v2, s[24:27], s56 offen offset:3072 sc1
  s_add_u32 s56, s56, 4096
  s_waitcnt lgkmcnt(2)
  v_mfma_f32_32x32x16_bf16 v[112:127], v[68:71], v[140:143], v[112:127]
  ds_read_b64_tr_b16 v[60:61], v11 offset:8192
  ds_read_b64_tr_b16 v[62:63], v11 offset:9216
  s_waitcnt vmcnt(7)
  s_waitcnt lgkmcnt(2)
  v_mfma_f32_32x32x16_bf16 v[96:111], v[56:59], v[144:147], v[96:111]
  ds_read_b64_tr_b16 v[64:65], v10 offset:10240
  ds_read_b64_tr_b16 v[66:67], v10 offset:11264
  buffer_load_dwordx4 v[176:179], v2, s[24:27], s56 offen offset:0 sc1
  s_waitcnt lgkmcnt(2)
  v_mfma_f32_32x32x16_bf16 v[112:127], v[60:63], v[144:147], v[112:127]
  ds_read_b64_tr_b16 v[68:69], v11 offset:10240
  ds_read_b64_tr_b16 v[70:71], v11 offset:11264
  s_waitcnt vmcnt(7)
  s_waitcnt lgkmcnt(2)
  v_mfma_f32_32x32x16_bf16 v[96:111], v[64:67], v[148:151], v[96:111]
  ds_read_b64_tr_b16 v[56:57], v10 offset:12288
  ds_read_b64_tr_b16 v[58:59], v10 offset:13312
  buffer_load_dwordx4 v[180:183], v2, s[24:27], s56 offen offset:1024 sc1
  s_waitcnt lgkmcnt(2)
  v_mfma_f32_32x32x16_bf16 v[112:127], v[68:71], v[148:151], v[112:127]
  ds_read_b64_tr_b16 v[60:61], v11 offset:12288
  ds_read_b64_tr_b16 v[62:63], v11 offset:13312
  s_waitcnt vmcnt(7)
  s_waitcnt lgkmcnt(2)
  v_mfma_f32_32x32x16_bf16 v[96:111], v[56:59], v[152:155], v[96:111]
  ds_read_b64_tr_b16 v[64:65], v10 offset:14336
  ds_read_b64_tr_b16 v[66:67], v10 offset:15360
  buffer_load_dwordx4 v[184:187], v2, s[24:27], s56 offen offset:2048 sc1
  s_waitcnt lgkmcnt(2)
  v_mfma_f32_32x32x16_bf16 v[112:127], v[60:63], v[152:155], v[112:127]
  ds_read_b64_tr_b16 v[68:69], v11 offset:14336
  ds_read_b64_tr_b16 v[70:71], v11 offset:15360
  s_waitcnt vmcnt(7)
  s_waitcnt lgkmcnt(2)
  v_mfma_f32_32x32x16_bf16 v[96:111], v[64:67], v[156:159], v[96:111]
  ds_read_b64_tr_b16 v[56:57], v10 offset:16384
  ds_read_b64_tr_b16 v[58:59], v10 offset:17408
  buffer_load_dwordx4 v[188:191], v2, s[24:27], s56 offen offset:3072 sc1
  s_add_u32 s56, s56, 4096
  s_waitcnt lgkmcnt(2)
  v_mfma_f32_32x32x16_bf16 v[112:127], v[68:71], v[156:159], v[112:127]
  ds_read_b64_tr_b16 v[60:61], v11 offset:16384
  ds_read_b64_tr_b16 v[62:63], v11 offset:17408
  s_waitcnt vmcnt(7)
  s_waitcnt lgkmcnt(2)
  v_mfma_f32_32x32x16_bf16 v[96:111], v[56:59], v[160:163], v[96:111]
  ds_read_b64_tr_b16 v[64:65], v10 offset:18432
  ds_read_b64_tr_b16 v[66:67], v10 offset:19456
  buffer_load_dwordx4 v[192:195], v2, s[24:27], s56 offen offset:0 sc1
  s_waitcnt lgkmcnt(2)
  v_mfma_f32_32x32x16_bf16 v[112:127], v[60:63], v[160:163], v[112:127]
  ds_read_b64_tr_b16 v[68:69], v11 offset:18432
  ds_read_b64_tr_b16 v[70:71], v11 offset:19456
  s_waitcnt vmcnt(7)
  s_waitcnt lgkmcnt(2)
  v_mfma_f32_32x32x16_bf16 v[96:111], v[64:67], v[164:167], v[96:111]
  ds_read_b64_tr_b16 v[56:57], v10 offset:20480
  ds_read_b64_tr_b16 v[58:59], v10 offset:21504
  buffer_load_dwordx4 v[196:199], v2, s[24:27], s56 offen offset:1024 sc1
  s_waitcnt lgkmcnt(2)
  v_mfma_f32_32x32x16_bf16 v[112:127], v[68:71], v[164:167], v[112:127]
  ds_read_b64_tr_b16 v[60:61], v11 offset:20480
  ds_read_b64_tr_b16 v[62:63], v11 offset:21504
  s_waitcnt vmcnt(7)
  s_waitcnt lgkmcnt(2)
  v_mfma_f32_32x32x16_bf16 v[96:111], v[56:59], v[168:171], v[96:111]
  ds_read_b64_tr_b16 v[64:65], v10 offset:22528
  ds_read_b64_tr_b16 v[66:67], v10 offset:23552
  buffer_load_dwordx4 v[200:203], v2, s[24:27], s56 offen offset:2048 sc1
  s_waitcnt lgkmcnt(2)
  v_mfma_f32_32x32x16_bf16 v[112:127], v[60:63], v[168:171], v[112:127]
  ds_read_b64_tr_b16 v[68:69], v11 offset:22528
  ds_read_b64_tr_b16 v[70:71], v11 offset:23552
  s_waitcnt vmcnt(7)
  s_waitcnt lgkmcnt(2)
  v_mfma_f32_32x32x16_bf16 v[96:111], v[64:67], v[172:175], v[96:111]
  ds_read_b64_tr_b16 v[56:57], v10 offset:24576
  ds_read_b64_tr_b16 v[58:59], v10 offset:25600
  buffer_load_dwordx4 v[204:207], v2, s[24:27], s56 offen offset:3072 sc1
  s_add_u32 s56, s56, 4096
  s_waitcnt lgkmcnt(2)
  v_mfma_f32_32x32x16_bf16 v[112:127], v[68:71], v[172:175], v[112:127]
  ds_read_b64_tr_b16 v[60:61], v11 offset:24576
  ds_read_b64_tr_b16 v[62:63], v11 offset:25600
  s_waitcnt vmcnt(7)
  s_waitcnt lgkmcnt(2)
  v_mfma_f32_32x32x16_bf16 v[96:111], v[56:59], v[176:179], v[96:111]
  ds_read_b64_tr_b16 v[64:65], v10 offset:26624
  ds_read_b64_tr_b16 v[66:67], v10 offset:27648
  buffer_load_dwordx4 v[208:211], v2, s[24:27], s56 offen offset:0 sc1
  s_waitcnt lgkmcnt(2)
  v_mfma_f32_32x32x16_bf16 v[112:127], v[60:63], v[176:179], v[112:127]
  ds_read_b64_tr_b16 v[68:69], v11 offset:26624
  ds_read_b64_tr_b16 v[70:71], v11 offset:27648
  buffer_load_dwordx4 v[32:35], v2, s[24:27], s57 offen offset:0 sc1
  s_waitcnt vmcnt(8)
  s_waitcnt lgkmcnt(2)
  v_mfma_f32_32x32x16_bf16 v[96:111], v[64:67], v[180:183], v[96:111]
  ds_read_b64_tr_b16 v[56:57], v10 offset:28672
  ds_read_b64_tr_b16 v[58:59], v10 offset:29696
  buffer_load_dwordx4 v[212:215], v2, s[24:27], s56 offen offset:1024 sc1
  s_waitcnt lgkmcnt(2)
  v_mfma_f32_32x32x16_bf16 v[112:127], v[68:71], v[180:183], v[112:127]
  ds_read_b64_tr_b16 v[60:61], v11 offset:28672
  ds_read_b64_tr_b16 v[62:63], v11 offset:29696
  buffer_load_dwordx4 v[36:39], v2, s[24:27], s57 offen offset:1024 sc1
  s_waitcnt vmcnt(9)
  s_waitcnt lgkmcnt(2)
  v_mfma_f32_32x32x16_bf16 v[96:111], v[56:59], v[184:187], v[96:111]
  ds_read_b64_tr_b16 v[64:65], v10 offset:30720
  ds_read_b64_tr_b16 v[66:67], v10 offset:31744
  buffer_load_dwordx4 v[216:219], v2, s[24:27], s56 offen offset:2048 sc1
  s_waitcnt lgkmcnt(2)
  v_mfma_f32_32x32x16_bf16 v[112:127], v[60:63], v[184:187], v[112:127]
  ds_read_b64_tr_b16 v[68:69], v11 offset:30720
  ds_read_b64_tr_b16 v[70:71], v11 offset:31744
  buffer_load_dwordx4 v[40:43], v2, s[24:27], s57 offen offset:2048 sc1
  s_barrier
  s_waitcnt vmcnt(10)
  s_waitcnt lgkmcnt(2)
  v_mfma_f32_32x32x16_bf16 v[96:111], v[64:67], v[188:191], v[96:111]
  ds_read_b64_tr_b16 v[56:57], v10 offset:32768
  ds_read_b64_tr_b16 v[58:59], v10 offset:33792
  buffer_load_dwordx4 v[220:223], v2, s[24:27], s56 offen offset:3072 sc1
  s_add_u32 s56, s56, 4096
  s_waitcnt lgkmcnt(2)
  v_mfma_f32_32x32x16_bf16 v[112:127], v[68:71], v[188:191], v[112:127]
  ds_read_b64_tr_b16 v[60:61], v11 offset:32768
  ds_read_b64_tr_b16 v[62:63], v11 offset:33792
  buffer_load_dwordx4 v[44:47], v2, s[24:27], s57 offen offset:3072 sc1
  s_waitcnt vmcnt(11)
  s_waitcnt lgkmcnt(2)
  v_mfma_f32_32x32x16_bf16 v[96:111], v[56:59], v[192:195], v[96:111]
  ds_read_b64_tr_b16 v[64:65], v10 offset:34816
  ds_read_b64_tr_b16 v[66:67], v10 offset:35840
  buffer_load_dwordx4 v[224:227], v2, s[24:27], s56 offen offset:0 sc1
  s_waitcnt lgkmcnt(2)
  v_mfma_f32_32x32x16_bf16 v[112:127], v[60:63], v[192:195], v[112:127]
  ds_read_b64_tr_b16 v[68:69], v11 offset:34816
  ds_read_b64_tr_b16 v[70:71], v11 offset:35840
  s_waitcnt vmcnt(11)
  s_waitcnt lgkmcnt(2)
  v_mfma_f32_32x32x16_bf16 v[96:111], v[64:67], v[196:199], v[96:111]
  ds_read_b64_tr_b16 v[56:57], v10 offset:36864
  ds_read_b64_tr_b16 v[58:59], v10 offset:37888
  buffer_load_dwordx4 v[228:231], v2, s[24:27], s56 offen offset:1024 sc1
  s_waitcnt lgkmcnt(2)
  v_mfma_f32_32x32x16_bf16 v[112:127], v[68:71], v[196:199], v[112:127]
  ds_read_b64_tr_b16 v[60:61], v11 offset:36864
  ds_read_b64_tr_b16 v[62:63], v11 offset:37888
  s_waitcnt vmcnt(11)
  s_waitcnt lgkmcnt(2)
  v_mfma_f32_32x32x16_bf16 v[96:111], v[56:59], v[200:203], v[96:111]
  ds_read_b64_tr_b16 v[64:65], v10 offset:38912
  ds_read_b64_tr_b16 v[66:67], v10 offset:39936
  buffer_load_dwordx4 v[232:235], v2, s[24:27], s56 offen offset:2048 sc1
  s_waitcnt lgkmcnt(2)
  v_mfma_f32_32x32x16_bf16 v[112:127], v[60:63], v[200:203], v[112:127]
  ds_read_b64_tr_b16 v[68:69], v11 offset:38912
  ds_read_b64_tr_b16 v[70:71], v11 offset:39936
  s_waitcnt vmcnt(11)
  s_waitcnt lgkmcnt(2)
  v_mfma_f32_32x32x16_bf16 v[96:111], v[64:67], v[204:207], v[96:111]
  ds_read_b64_tr_b16 v[56:57], v10 offset:40960
  ds_read_b64_tr_b16 v[58:59], v10 offset:41984
  buffer_load_dwordx4 v[236:239], v2, s[24:27], s56 offen offset:3072 sc1
  s_add_u32 s56, s56, 4096
  s_waitcnt lgkmcnt(2)
  v_mfma_f32_32x32x16_bf16 v[112:127], v[68:71], v[204:207], v[112:127]
  ds_read_b64_tr_b16 v[60:61], v11 offset:40960
  ds_read_b64_tr_b16 v[62:63], v11 offset:41984
  s_waitcnt vmcnt(11)
  s_waitcnt lgkmcnt(2)
  v_mfma_f32_32x32x16_bf16 v[96:111], v[56:59], v[208:211], v[96:111]
  ds_read_b64_tr_b16 v[64:65], v10 offset:43008
  ds_read_b64_tr_b16 v[66:67], v10 offset:44032
  buffer_load_dwordx4 v[240:243], v2, s[24:27], s56 offen offset:0 sc1
  s_waitcnt lgkmcnt(2)
  v_mfma_f32_32x32x16_bf16 v[112:127], v[60:63], v[208:211], v[112:127]
  ds_read_b64_tr_b16 v[68:69], v11 offset:43008
  ds_read_b64_tr_b16 v[70:71], v11 offset:44032
  v_mov_b32 v14, 163836
  v_mov_b32 v15, 1
  ds_write_b32 v14, v15
  s_waitcnt vmcnt(10)
  s_waitcnt lgkmcnt(2)
  v_mfma_f32_32x32x16_bf16 v[96:111], v[64:67], v[212:215], v[96:111]
  ds_read_b64_tr_b16 v[56:57], v10 offset:45056
  ds_read_b64_tr_b16 v[58:59], v10 offset:46080
  buffer_load_dwordx4 v[244:247], v2, s[24:27], s56 offen offset:1024 sc1
  s_waitcnt lgkmcnt(2)
  v_mfma_f32_32x32x16_bf16 v[112:127], v[68:71], v[212:215], v[112:127]
  ds_read_b64_tr_b16 v[60:61], v11 offset:45056
  ds_read_b64_tr_b16 v[62:63], v11 offset:46080
  s_waitcnt vmcnt(9)
  s_waitcnt lgkmcnt(2)
  v_mfma_f32_32x32x16_bf16 v[96:111], v[56:59], v[216:219], v[96:111]
  ds_read_b64_tr_b16 v[64:65], v10 offset:47104
  ds_read_b64_tr_b16 v[66:67], v10 offset:48128
  buffer_load_dwordx4 v[248:251], v2, s[24:27], s56 offen offset:2048 sc1
  s_waitcnt lgkmcnt(2)
  v_mfma_f32_32x32x16_bf16 v[112:127], v[60:63], v[216:219], v[112:127]
  ds_read_b64_tr_b16 v[68:69], v11 offset:47104
  ds_read_b64_tr_b16 v[70:71], v11 offset:48128
  s_waitcnt vmcnt(8)
  s_waitcnt lgkmcnt(2)
  v_mfma_f32_32x32x16_bf16 v[96:111], v[64:67], v[220:223], v[96:111]
  ds_read_b64_tr_b16 v[56:57], v10 offset:49152
  ds_read_b64_tr_b16 v[58:59], v10 offset:50176
  buffer_load_dwordx4 v[252:255], v2, s[24:27], s56 offen offset:3072 sc1
  s_add_u32 s56, s56, 4096
  s_waitcnt lgkmcnt(2)
  v_mfma_f32_32x32x16_bf16 v[112:127], v[68:71], v[220:223], v[112:127]
  ds_read_b64_tr_b16 v[60:61], v11 offset:49152
  ds_read_b64_tr_b16 v[62:63], v11 offset:50176
  s_waitcnt vmcnt(7)
  s_waitcnt lgkmcnt(2)
  v_mfma_f32_32x32x16_bf16 v[96:111], v[56:59], v[224:227], v[96:111]
  ds_read_b64_tr_b16 v[64:65], v10 offset:51200
  ds_read_b64_tr_b16 v[66:67], v10 offset:52224
  s_waitcnt lgkmcnt(2)
  v_mfma_f32_32x32x16_bf16 v[112:127], v[60:63], v[224:227], v[112:127]
  ds_read_b64_tr_b16 v[68:69], v11 offset:51200
  ds_read_b64_tr_b16 v[70:71], v11 offset:52224
  v_pk_add_f32 v[32:33], v[32:33], v[40:41]
  v_pk_add_f32 v[34:35], v[34:35], v[42:43]
  v_pk_add_f32 v[36:37], v[36:37], v[44:45]
  s_waitcnt vmcnt(6)
  s_waitcnt lgkmcnt(2)
  v_mfma_f32_32x32x16_bf16 v[96:111], v[64:67], v[228:231], v[96:111]
  ds_read_b64_tr_b16 v[56:57], v10 offset:53248
  ds_read_b64_tr_b16 v[58:59], v10 offset:54272
  v_pk_add_f32 v[38:39], v[38:39], v[46:47]
  v_pk_add_f32 v[32:33], v[32:33], v[36:37]
  v_pk_add_f32 v[34:35], v[34:35], v[38:39]
  s_waitcnt lgkmcnt(2)
  v_mfma_f32_32x32x16_bf16 v[112:127], v[68:71], v[228:231], v[112:127]
  ds_read_b64_tr_b16 v[60:61], v11 offset:53248
  ds_read_b64_tr_b16 v[62:63], v11 offset:54272
  v_pk_add_f32 v[32:33], v[32:33], v[34:35]
  v_add_f32 v32, v32, v33
  v_mov_b32 v33, v32
  s_waitcnt vmcnt(5)
  s_waitcnt lgkmcnt(2)
  v_mfma_f32_32x32x16_bf16 v[96:111], v[56:59], v[232:235], v[96:111]
  ds_read_b64_tr_b16 v[64:65], v10 offset:55296
  ds_read_b64_tr_b16 v[66:67], v10 offset:56320
  v_permlane32_swap_b32 v32, v33
  v_mul_f32 v32, 0x3b000000, v32
  v_mul_f32 v33, 0x3b000000, v33
  s_waitcnt lgkmcnt(2)
  v_mfma_f32_32x32x16_bf16 v[112:127], v[60:63], v[232:235], v[112:127]
  ds_read_b64_tr_b16 v[68:69], v11 offset:55296
  ds_read_b64_tr_b16 v[70:71], v11 offset:56320
  v_fma_f32 v33, -v32, v32, v33
  v_max_f32 v33, 0, v33
  v_mov_b32 v36, v32
  s_waitcnt vmcnt(4)
  s_waitcnt lgkmcnt(2)
  v_mfma_f32_32x32x16_bf16 v[96:111], v[64:67], v[236:239], v[96:111]
  ds_read_b64_tr_b16 v[56:57], v10 offset:57344
  ds_read_b64_tr_b16 v[58:59], v10 offset:58368
  v_cvt_pk_bf16_f32 v36, v36, v36
  v_lshlrev_b32 v36, 16, v36
  v_mov_b32 v34, v33
  s_waitcnt lgkmcnt(2)
  v_mfma_f32_32x32x16_bf16 v[112:127], v[68:71], v[236:239], v[112:127]
  ds_read_b64_tr_b16 v[60:61], v11 offset:57344
  ds_read_b64_tr_b16 v[62:63], v11 offset:58368
  v_cvt_pk_bf16_f32 v34, v34, v34
  v_lshlrev_b32 v34, 16, v34
  v_add_f32 v34, 0x3727c5ac, v34
  s_waitcnt vmcnt(3)
  s_waitcnt lgkmcnt(2)
  v_mfma_f32_32x32x16_bf16 v[96:111], v[56:59], v[240:243], v[96:111]
  ds_read_b64_tr_b16 v[64:65], v10 offset:59392
  ds_read_b64_tr_b16 v[66:67], v10 offset:60416
  v_cvt_pk_bf16_f32 v34, v34, v34
  v_lshlrev_b32 v34, 16, v34
  v_sqrt_f32 v34, v34
  s_waitcnt lgkmcnt(2)
  v_mfma_f32_32x32x16_bf16 v[112:127], v[60:63], v[240:243], v[112:127]
  ds_read_b64_tr_b16 v[68:69], v11 offset:59392
  ds_read_b64_tr_b16 v[70:71], v11 offset:60416
  v_cvt_pk_bf16_f32 v34, v34, v34
  v_lshlrev_b32 v34, 16, v34
  v_rcp_f32 v37, v34
  s_waitcnt vmcnt(2)
  s_waitcnt lgkmcnt(2)
  v_mfma_f32_32x32x16_bf16 v[96:111], v[64:67], v[244:247], v[96:111]
  ds_read_b64_tr_b16 v[56:57], v10 offset:61440
  ds_read_b64_tr_b16 v[58:59], v10 offset:62464
  v_mul_f32 v8, 1.0, v37
  v_mov_b32 v32, v36
  v_mul_f32 v9, v32, v8
  s_waitcnt lgkmcnt(2)
  v_mfma_f32_32x32x16_bf16 v[112:127], v[68:71], v[244:247], v[112:127]
  ds_read_b64_tr_b16 v[60:61], v11 offset:61440
  ds_read_b64_tr_b16 v[62:63], v11 offset:62464
  v_sub_f32 v9, 0, v9
  s_waitcnt vmcnt(1)
  s_waitcnt lgkmcnt(2)
  v_mfma_f32_32x32x16_bf16 v[96:111], v[56:59], v[248:251], v[96:111]
  ds_read_b64_tr_b16 v[64:65], v10 offset:63488
  ds_read_b64_tr_b16 v[66:67], v10 offset:64512
  s_waitcnt lgkmcnt(2)
  v_mfma_f32_32x32x16_bf16 v[112:127], v[60:63], v[248:251], v[112:127]
  ds_read_b64_tr_b16 v[68:69], v11 offset:63488
  ds_read_b64_tr_b16 v[70:71], v11 offset:64512
  s_waitcnt vmcnt(0)
  s_waitcnt lgkmcnt(2)
  v_mfma_f32_32x32x16_bf16 v[96:111], v[64:67], v[252:255], v[96:111]
  s_waitcnt lgkmcnt(0)
  v_mfma_f32_32x32x16_bf16 v[112:127], v[68:71], v[252:255], v[112:127]
  s_barrier
  ds_read_b128 v[32:35], v13 offset:128
  ds_read_b128 v[36:39], v13 offset:160
  ds_read_b128 v[40:43], v13 offset:192
  ds_read_b128 v[44:47], v13 offset:224
  ds_read_b128 v[16:19], v13 offset:256
  ds_read_b128 v[20:23], v13 offset:288
  ds_read_b128 v[24:27], v13 offset:320
  ds_read_b128 v[28:31], v13 offset:352
  s_waitcnt lgkmcnt(0)
  v_pk_mul_f32 v[32:33], v[32:33], v[8:9] op_sel:[0,1] op_sel_hi:[1,1]
  v_pk_mul_f32 v[34:35], v[34:35], v[8:9] op_sel:[0,1] op_sel_hi:[1,1]
  v_pk_mul_f32 v[36:37], v[36:37], v[8:9] op_sel:[0,1] op_sel_hi:[1,1]
  v_pk_mul_f32 v[38:39], v[38:39], v[8:9] op_sel:[0,1] op_sel_hi:[1,1]
  v_pk_mul_f32 v[40:41], v[40:41], v[8:9] op_sel:[0,1] op_sel_hi:[1,1]
  v_pk_mul_f32 v[42:43], v[42:43], v[8:9] op_sel:[0,1] op_sel_hi:[1,1]
  v_pk_mul_f32 v[44:45], v[44:45], v[8:9] op_sel:[0,1] op_sel_hi:[1,1]
  v_pk_mul_f32 v[46:47], v[46:47], v[8:9] op_sel:[0,1] op_sel_hi:[1,1]
  v_pk_fma_f32 v[96:97], v[96:97], v[8:9], v[32:33] op_sel_hi:[1,0,1]
  v_pk_fma_f32 v[98:99], v[98:99], v[8:9], v[34:35] op_sel_hi:[1,0,1]
  v_pk_fma_f32 v[100:101], v[100:101], v[8:9], v[36:37] op_sel_hi:[1,0,1]
  v_pk_fma_f32 v[102:103], v[102:103], v[8:9], v[38:39] op_sel_hi:[1,0,1]
  v_pk_fma_f32 v[104:105], v[104:105], v[8:9], v[40:41] op_sel_hi:[1,0,1]
  v_pk_fma_f32 v[106:107], v[106:107], v[8:9], v[42:43] op_sel_hi:[1,0,1]
  v_pk_fma_f32 v[108:109], v[108:109], v[8:9], v[44:45] op_sel_hi:[1,0,1]
  v_pk_fma_f32 v[110:111], v[110:111], v[8:9], v[46:47] op_sel_hi:[1,0,1]
  v_cvt_pk_bf16_f32 v48, v96, v97
  v_cvt_pk_bf16_f32 v49, v98, v99
  v_cvt_pk_bf16_f32 v50, v100, v101
  v_cvt_pk_bf16_f32 v51, v102, v103
  v_cvt_pk_bf16_f32 v52, v104, v105
  v_cvt_pk_bf16_f32 v53, v106, v107
  v_cvt_pk_bf16_f32 v54, v108, v109
  v_cvt_pk_bf16_f32 v55, v110, v111
  buffer_store_dwordx4 v[48:51], v12, s[24:27], s60 offen offset:0 sc0 sc1
  buffer_store_dwordx4 v[52:55], v12, s[24:27], s60 offen offset:1024 sc0 sc1
  v_pk_mul_f32 v[16:17], v[16:17], v[8:9] op_sel:[0,1] op_sel_hi:[1,1]
  v_pk_mul_f32 v[18:19], v[18:19], v[8:9] op_sel:[0,1] op_sel_hi:[1,1]
  v_pk_mul_f32 v[20:21], v[20:21], v[8:9] op_sel:[0,1] op_sel_hi:[1,1]
  v_pk_mul_f32 v[22:23], v[22:23], v[8:9] op_sel:[0,1] op_sel_hi:[1,1]
  v_pk_mul_f32 v[24:25], v[24:25], v[8:9] op_sel:[0,1] op_sel_hi:[1,1]
  v_pk_mul_f32 v[26:27], v[26:27], v[8:9] op_sel:[0,1] op_sel_hi:[1,1]
  v_pk_mul_f32 v[28:29], v[28:29], v[8:9] op_sel:[0,1] op_sel_hi:[1,1]
  v_pk_mul_f32 v[30:31], v[30:31], v[8:9] op_sel:[0,1] op_sel_hi:[1,1]
  v_pk_fma_f32 v[112:113], v[112:113], v[8:9], v[16:17] op_sel_hi:[1,0,1]
  v_pk_fma_f32 v[114:115], v[114:115], v[8:9], v[18:19] op_sel_hi:[1,0,1]
  v_pk_fma_f32 v[116:117], v[116:117], v[8:9], v[20:21] op_sel_hi:[1,0,1]
  v_pk_fma_f32 v[118:119], v[118:119], v[8:9], v[22:23] op_sel_hi:[1,0,1]
  v_pk_fma_f32 v[120:121], v[120:121], v[8:9], v[24:25] op_sel_hi:[1,0,1]
  v_pk_fma_f32 v[122:123], v[122:123], v[8:9], v[26:27] op_sel_hi:[1,0,1]
  v_pk_fma_f32 v[124:125], v[124:125], v[8:9], v[28:29] op_sel_hi:[1,0,1]
  v_pk_fma_f32 v[126:127], v[126:127], v[8:9], v[30:31] op_sel_hi:[1,0,1]
  v_cvt_pk_bf16_f32 v56, v112, v113
  v_cvt_pk_bf16_f32 v57, v114, v115
  v_cvt_pk_bf16_f32 v58, v116, v117
  v_cvt_pk_bf16_f32 v59, v118, v119
  v_cvt_pk_bf16_f32 v60, v120, v121
  v_cvt_pk_bf16_f32 v61, v122, v123
  v_cvt_pk_bf16_f32 v62, v124, v125
  v_cvt_pk_bf16_f32 v63, v126, v127
  buffer_store_dwordx4 v[56:59], v12, s[24:27], s60 offen offset:2048 sc0 sc1
  buffer_store_dwordx4 v[60:63], v12, s[24:27], s60 offen offset:3072 sc0 sc1
  s_cmp_eq_u32 s45, 0
  s_cbranch_scc1 Lgs_14
  buffer_store_dwordx4 v[48:51], v12, s[24:27], s59 offen offset:0
  buffer_store_dwordx4 v[52:55], v12, s[24:27], s59 offen offset:1024
  s_branch Lgsd_15
Lgs_14:
  buffer_store_dwordx4 v[48:51], v12, s[24:27], s59 offen offset:0 sc1
  buffer_store_dwordx4 v[52:55], v12, s[24:27], s59 offen offset:1024 sc1
Lgsd_15:
  s_cmp_eq_u32 s45, 0
  s_cbranch_scc1 Lgs_16
  buffer_store_dwordx4 v[56:59], v12, s[24:27], s59 offen offset:2048
  buffer_store_dwordx4 v[60:63], v12, s[24:27], s59 offen offset:3072
  s_branch Lgsd_17
Lgs_16:
  buffer_store_dwordx4 v[56:59], v12, s[24:27], s59 offen offset:2048 sc1
  buffer_store_dwordx4 v[60:63], v12, s[24:27], s59 offen offset:3072 sc1
Lgsd_17:
  s_cmp_lg_u32 s47, 0
  s_cbranch_scc1 Lbl0_18
  s_barrier
Lbl0_18:
  s_cmp_eq_u32 s47, 0
  s_cbranch_scc1 Ltq_19
  ds_read_b128 v[32:35], v13 offset:0
  ds_read_b128 v[36:39], v13 offset:32
  ds_read_b128 v[40:43], v13 offset:64
  ds_read_b128 v[44:47], v13 offset:96
Ltq_19:
  ds_read_b64_tr_b16 v[56:57], v4 offset:0
  ds_read_b64_tr_b16 v[58:59], v4 offset:512
  ds_read_b64_tr_b16 v[60:61], v4 offset:1024
  ds_read_b64_tr_b16 v[62:63], v4 offset:1536
  ds_read_b64_tr_b16 v[64:65], v4 offset:2048
  ds_read_b64_tr_b16 v[66:67], v4 offset:2560
  s_waitcnt lgkmcnt(4)
  v_mfma_f32_32x32x16_bf16 v[80:95], v[56:59], v[128:131], 0
  ds_read_b64_tr_b16 v[68:69], v4 offset:3072
  ds_read_b64_tr_b16 v[70:71], v4 offset:3584
  s_waitcnt lgkmcnt(4)
  v_mfma_f32_32x32x16_bf16 v[80:95], v[60:63], v[132:135], v[80:95]
  ds_read_b64_tr_b16 v[56:57], v4 offset:4096
  ds_read_b64_tr_b16 v[58:59], v4 offset:4608
  s_waitcnt lgkmcnt(4)
  v_mfma_f32_32x32x16_bf16 v[80:95], v[64:67], v[136:139], v[80:95]
  ds_read_b64_tr_b16 v[60:61], v4 offset:5120
  ds_read_b64_tr_b16 v[62:63], v4 offset:5632
  s_waitcnt lgkmcnt(4)
  v_mfma_f32_32x32x16_bf16 v[80:95], v[68:71], v[140:143], v[80:95]
  ds_read_b64_tr_b16 v[64:65], v4 offset:6144
  ds_read_b64_tr_b16 v[66:67], v4 offset:6656
  s_waitcnt lgkmcnt(4)
  v_mfma_f32_32x32x16_bf16 v[80:95], v[56:59], v[144:147], v[80:95]
  ds_read_b64_tr_b16 v[68:69], v4 offset:7168
  ds_read_b64_tr_b16 v[70:71], v4 offset:7680
  s_waitcnt lgkmcnt(4)
  v_mfma_f32_32x32x16_bf16 v[80:95], v[60:63], v[148:151], v[80:95]
  ds_read_b64_tr_b16 v[56:57], v4 offset:8192
  ds_read_b64_tr_b16 v[58:59], v4 offset:8704
  s_waitcnt lgkmcnt(4)
  v_mfma_f32_32x32x16_bf16 v[80:95], v[64:67], v[152:155], v[80:95]
  ds_read_b64_tr_b16 v[60:61], v4 offset:9216
  ds_read_b64_tr_b16 v[62:63], v4 offset:9728
  s_waitcnt lgkmcnt(4)
  v_mfma_f32_32x32x16_bf16 v[80:95], v[68:71], v[156:159], v[80:95]
  ds_read_b64_tr_b16 v[64:65], v4 offset:10240
  ds_read_b64_tr_b16 v[66:67], v4 offset:10752
  s_waitcnt lgkmcnt(4)
  v_mfma_f32_32x32x16_bf16 v[80:95], v[56:59], v[160:163], v[80:95]
  ds_read_b64_tr_b16 v[68:69], v4 offset:11264
  ds_read_b64_tr_b16 v[70:71], v4 offset:11776
  s_waitcnt lgkmcnt(4)
  v_mfma_f32_32x32x16_bf16 v[80:95], v[60:63], v[164:167], v[80:95]
  ds_read_b64_tr_b16 v[56:57], v4 offset:12288
  ds_read_b64_tr_b16 v[58:59], v4 offset:12800
  s_waitcnt lgkmcnt(4)
  v_mfma_f32_32x32x16_bf16 v[80:95], v[64:67], v[168:171], v[80:95]
  ds_read_b64_tr_b16 v[60:61], v4 offset:13312
  ds_read_b64_tr_b16 v[62:63], v4 offset:13824
  s_waitcnt lgkmcnt(4)
  v_mfma_f32_32x32x16_bf16 v[80:95], v[68:71], v[172:175], v[80:95]
  ds_read_b64_tr_b16 v[64:65], v4 offset:14336
  ds_read_b64_tr_b16 v[66:67], v4 offset:14848
  s_waitcnt lgkmcnt(4)
  v_mfma_f32_32x32x16_bf16 v[80:95], v[56:59], v[176:179], v[80:95]
  ds_read_b64_tr_b16 v[68:69], v4 offset:15360
  ds_read_b64_tr_b16 v[70:71], v4 offset:15872
  s_waitcnt lgkmcnt(4)
  v_mfma_f32_32x32x16_bf16 v[80:95], v[60:63], v[180:183], v[80:95]
  ds_read_b64_tr_b16 v[56:57], v4 offset:16384
  ds_read_b64_tr_b16 v[58:59], v4 offset:16896
  s_waitcnt lgkmcnt(4)
  v_mfma_f32_32x32x16_bf16 v[80:95], v[64:67], v[184:187], v[80:95]
  ds_read_b64_tr_b16 v[60:61], v4 offset:17408
  ds_read_b64_tr_b16 v[62:63], v4 offset:17920
  s_waitcnt lgkmcnt(4)
  v_mfma_f32_32x32x16_bf16 v[80:95], v[68:71], v[188:191], v[80:95]
  ds_read_b64_tr_b16 v[64:65], v4 offset:18432
  ds_read_b64_tr_b16 v[66:67], v4 offset:18944
  s_waitcnt lgkmcnt(4)
  v_mfma_f32_32x32x16_bf16 v[80:95], v[56:59], v[192:195], v[80:95]
  ds_read_b64_tr_b16 v[68:69], v4 offset:19456
  ds_read_b64_tr_b16 v[70:71], v4 offset:19968
  s_cmp_lg_u32 s47, 0
  s_cbranch_scc1 Lbl0_20
  s_barrier
Lbl0_20:
  s_waitcnt lgkmcnt(4)
  v_mfma_f32_32x32x16_bf16 v[80:95], v[60:63], v[196:199], v[80:95]
  ds_read_b64_tr_b16 v[56:57], v4 offset:20480
  ds_read_b64_tr_b16 v[58:59], v4 offset:20992
  s_waitcnt lgkmcnt(4)
  v_mfma_f32_32x32x16_bf16 v[80:95], v[64:67], v[200:203], v[80:95]
  ds_read_b64_tr_b16 v[60:61], v4 offset:21504
  ds_read_b64_tr_b16 v[62:63], v4 offset:22016
  s_waitcnt lgkmcnt(4)
  v_mfma_f32_32x32x16_bf16 v[80:95], v[68:71], v[204:207], v[80:95]
  ds_read_b64_tr_b16 v[64:65], v4 offset:22528
  ds_read_b64_tr_b16 v[66:67], v4 offset:23040
  s_waitcnt lgkmcnt(4)
  v_mfma_f32_32x32x16_bf16 v[80:95], v[56:59], v[208:211], v[80:95]
  ds_read_b64_tr_b16 v[68:69], v4 offset:23552
  ds_read_b64_tr_b16 v[70:71], v4 offset:24064
  s_waitcnt lgkmcnt(4)
  v_mfma_f32_32x32x16_bf16 v[80:95], v[60:63], v[212:215], v[80:95]
  ds_read_b64_tr_b16 v[56:57], v4 offset:24576
  ds_read_b64_tr_b16 v[58:59], v4 offset:25088
  s_waitcnt lgkmcnt(4)
  v_mfma_f32_32x32x16_bf16 v[80:95], v[64:67], v[216:219], v[80:95]
  ds_read_b64_tr_b16 v[60:61], v4 offset:25600
  ds_read_b64_tr_b16 v[62:63], v4 offset:26112
  s_waitcnt lgkmcnt(4)
  v_mfma_f32_32x32x16_bf16 v[80:95], v[68:71], v[220:223], v[80:95]
  ds_read_b64_tr_b16 v[64:65], v4 offset:26624
  ds_read_b64_tr_b16 v[66:67], v4 offset:27136
  s_waitcnt lgkmcnt(4)
  v_mfma_f32_32x32x16_bf16 v[80:95], v[56:59], v[224:227], v[80:95]
  ds_read_b64_tr_b16 v[68:69], v4 offset:27648
  ds_read_b64_tr_b16 v[70:71], v4 offset:28160
  s_waitcnt lgkmcnt(4)
  v_mfma_f32_32x32x16_bf16 v[80:95], v[60:63], v[228:231], v[80:95]
  ds_read_b64_tr_b16 v[56:57], v4 offset:28672
  ds_read_b64_tr_b16 v[58:59], v4 offset:29184
  s_waitcnt lgkmcnt(4)
  v_mfma_f32_32x32x16_bf16 v[80:95], v[64:67], v[232:235], v[80:95]
  ds_read_b64_tr_b16 v[60:61], v4 offset:29696
  ds_read_b64_tr_b16 v[62:63], v4 offset:30208
  s_waitcnt lgkmcnt(4)
  v_mfma_f32_32x32x16_bf16 v[80:95], v[68:71], v[236:239], v[80:95]
  ds_read_b64_tr_b16 v[64:65], v4 offset:30720
  ds_read_b64_tr_b16 v[66:67], v4 offset:31232
  s_waitcnt lgkmcnt(4)
  v_mfma_f32_32x32x16_bf16 v[80:95], v[56:59], v[240:243], v[80:95]
  ds_read_b64_tr_b16 v[68:69], v4 offset:31744
  ds_read_b64_tr_b16 v[70:71], v4 offset:32256
  s_waitcnt lgkmcnt(4)
  v_mfma_f32_32x32x16_bf16 v[80:95], v[60:63], v[244:247], v[80:95]
  s_waitcnt lgkmcnt(2)
  v_mfma_f32_32x32x16_bf16 v[80:95], v[64:67], v[248:251], v[80:95]
  s_waitcnt lgkmcnt(0)
  v_mfma_f32_32x32x16_bf16 v[80:95], v[68:71], v[252:255], v[80:95]
  s_waitcnt vmcnt(4)
  s_mov_b64 exec, 1
  v_mov_b32 v14, s43
  v_mov_b32 v15, 0
  buffer_store_dword v14, v15, s[24:27], s62 offen sc1
  s_mov_b64 exec, -1
  s_cmp_lg_u32 s47, 0
  s_cbranch_scc1 Ltq0_21
  s_barrier
  ds_read_b128 v[32:35], v13 offset:0
  ds_read_b128 v[36:39], v13 offset:32
  ds_read_b128 v[40:43], v13 offset:64
  ds_read_b128 v[44:47], v13 offset:96
Ltq0_21:
  s_waitcnt lgkmcnt(0)
  v_mul_f32 v8, 0x3eb8aa3b, v8
  v_mul_f32 v9, 0x3eb8aa3b, v9
  v_pk_mul_f32 v[32:33], v[32:33], v[8:9] op_sel:[0,1] op_sel_hi:[1,1]
  v_pk_mul_f32 v[34:35], v[34:35], v[8:9] op_sel:[0,1] op_sel_hi:[1,1]
  v_pk_mul_f32 v[36:37], v[36:37], v[8:9] op_sel:[0,1] op_sel_hi:[1,1]
  v_pk_mul_f32 v[38:39], v[38:39], v[8:9] op_sel:[0,1] op_sel_hi:[1,1]
  v_pk_mul_f32 v[40:41], v[40:41], v[8:9] op_sel:[0,1] op_sel_hi:[1,1]
  v_pk_mul_f32 v[42:43], v[42:43], v[8:9] op_sel:[0,1] op_sel_hi:[1,1]
  v_pk_mul_f32 v[44:45], v[44:45], v[8:9] op_sel:[0,1] op_sel_hi:[1,1]
  v_pk_mul_f32 v[46:47], v[46:47], v[8:9] op_sel:[0,1] op_sel_hi:[1,1]
  v_pk_fma_f32 v[80:81], v[80:81], v[8:9], v[32:33] op_sel_hi:[1,0,1]
  v_pk_fma_f32 v[82:83], v[82:83], v[8:9], v[34:35] op_sel_hi:[1,0,1]
  v_pk_fma_f32 v[84:85], v[84:85], v[8:9], v[36:37] op_sel_hi:[1,0,1]
  v_pk_fma_f32 v[86:87], v[86:87], v[8:9], v[38:39] op_sel_hi:[1,0,1]
  v_pk_fma_f32 v[88:89], v[88:89], v[8:9], v[40:41] op_sel_hi:[1,0,1]
  v_pk_fma_f32 v[90:91], v[90:91], v[8:9], v[42:43] op_sel_hi:[1,0,1]
  v_pk_fma_f32 v[92:93], v[92:93], v[8:9], v[44:45] op_sel_hi:[1,0,1]
  v_pk_fma_f32 v[94:95], v[94:95], v[8:9], v[46:47] op_sel_hi:[1,0,1]
  v_cvt_pk_bf16_f32 v48, v80, v81
  v_cvt_pk_bf16_f32 v49, v82, v83
  v_cvt_pk_bf16_f32 v50, v84, v85
  v_cvt_pk_bf16_f32 v51, v86, v87
  v_cvt_pk_bf16_f32 v52, v88, v89
  v_cvt_pk_bf16_f32 v53, v90, v91
  v_cvt_pk_bf16_f32 v54, v92, v93
  v_cvt_pk_bf16_f32 v55, v94, v95
  s_cmp_eq_u32 s45, 0
  s_cbranch_scc1 Lgs_22
  buffer_store_dwordx4 v[48:51], v2, s[24:27], s61 offen
  buffer_store_dwordx4 v[52:55], v2, s[24:27], s61 offen offset:1024
  s_branch Lgsd_23
Lgs_22:
  buffer_store_dwordx4 v[48:51], v2, s[24:27], s61 offen sc1
  buffer_store_dwordx4 v[52:55], v2, s[24:27], s61 offen offset:1024 sc1
Lgsd_23:
  s_waitcnt vmcnt(0)
  s_mov_b64 exec, 1
  v_mov_b32 v14, s43
  v_mov_b32 v15, 0
  s_cmp_eq_u32 s45, 0
  s_cbranch_scc1 Lgs_24
  buffer_store_dword v14, v15, s[24:27], s64 offen
  s_branch Lgsd_25
Lgs_24:
  buffer_store_dword v14, v15, s[24:27], s64 offen sc1
Lgsd_25:
  s_mov_b64 exec, -1
  s_mov_b64 exec, 1
  v_mov_b32 v14, s43
  v_mov_b32 v15, 0
  s_cmp_eq_u32 s45, 0
  s_cbranch_scc1 Lgs_26
  buffer_store_dword v14, v15, s[24:27], s63 offen
  s_branch Lgsd_27
Lgs_26:
  buffer_store_dword v14, v15, s[24:27], s63 offen sc1
Lgsd_27:
  s_mov_b64 exec, -1
  s_branch L_qkv_d
L_qkv_h:
  s_cmp_eq_u32 s42, 7
  s_cbranch_scc1 Lh7_28
  s_cmp_lg_u32 s47, 0
  s_cbranch_scc1 Lh7_28
  s_waitcnt vmcnt(16)
Lh7_28:
  s_waitcnt lgkmcnt(0)
  s_barrier
  v_mov_b32 v14, 163832
  ds_read_b32 v14, v14
  s_waitcnt lgkmcnt(0)
  v_readfirstlane_b32 s45, v14
  s_cmp_lg_u32 s47, 0
  s_cbranch_scc1 Lhl1_29
  s_cmp_eq_u32 s42, 4
  s_cbranch_scc1 Lha_30
  s_cmp_eq_u32 s42, 7
  s_cbranch_scc1 Lha_30
  s_sub_u32 s50, s42, 5
  s_lshl_b32 s50, s50, 6
  v_xor_b32 v8, s50, v6
  v_add_u32 v8, 32768, v8
  s_cmp_eq_u32 s42, 7
  s_mov_b32 s51, 1024
  s_cselect_b32 s54, s51, 2048
  s_cselect_b32 s51, 512, s51
  s_cselect_b64 vcc, -1, 0
  v_cndmask_b32 v8, v8, v4, vcc
  v_add_u32 v9, s51, v8
  v_mov_b32 v48, 0
  v_mov_b32 v49, 0
  v_mov_b32 v50, 0
  v_mov_b32 v51, 0
  v_mov_b32 v11, 0x3f803f80
  ds_read_b64_tr_b16 v[16:17], v8
  ds_read_b64_tr_b16 v[18:19], v9
  v_add_u32 v8, s54, v8
  v_add_u32 v9, s54, v9
  ds_read_b64_tr_b16 v[20:21], v8
  ds_read_b64_tr_b16 v[22:23], v9
  v_add_u32 v8, s54, v8
  v_add_u32 v9, s54, v9
  ds_read_b64_tr_b16 v[24:25], v8
  ds_read_b64_tr_b16 v[26:27], v9
  v_add_u32 v8, s54, v8
  v_add_u32 v9, s54, v9
  ds_read_b64_tr_b16 v[28:29], v8
  ds_read_b64_tr_b16 v[30:31], v9
  v_add_u32 v8, s54, v8
  v_add_u32 v9, s54, v9
  ds_read_b64_tr_b16 v[32:33], v8
  ds_read_b64_tr_b16 v[34:35], v9
  v_add_u32 v8, s54, v8
  v_add_u32 v9, s54, v9
  ds_read_b64_tr_b16 v[36:37], v8
  ds_read_b64_tr_b16 v[38:39], v9
  v_add_u32 v8, s54, v8
  v_add_u32 v9, s54, v9
  ds_read_b64_tr_b16 v[40:41], v8
  ds_read_b64_tr_b16 v[42:43], v9
  v_add_u32 v8, s54, v8
  v_add_u32 v9, s54, v9
  ds_read_b64_tr_b16 v[44:45], v8
  ds_read_b64_tr_b16 v[46:47], v9
  v_add_u32 v8, s54, v8
  v_add_u32 v9, s54, v9
  s_waitcnt lgkmcnt(14)
  v_dot2c_f32_bf16 v48, v16, v11
  v_dot2c_f32_bf16 v49, v17, v11
  v_dot2c_f32_bf16 v50, v18, v11
  v_dot2c_f32_bf16 v51, v19, v11
  s_waitcnt lgkmcnt(12)
  v_dot2c_f32_bf16 v48, v20, v11
  v_dot2c_f32_bf16 v49, v21, v11
  v_dot2c_f32_bf16 v50, v22, v11
  v_dot2c_f32_bf16 v51, v23, v11
  s_waitcnt lgkmcnt(10)
  v_dot2c_f32_bf16 v48, v24, v11
  v_dot2c_f32_bf16 v49, v25, v11
  v_dot2c_f32_bf16 v50, v26, v11
  v_dot2c_f32_bf16 v51, v27, v11
  s_waitcnt lgkmcnt(8)
  v_dot2c_f32_bf16 v48, v28, v11
  v_dot2c_f32_bf16 v49, v29, v11
  v_dot2c_f32_bf16 v50, v30, v11
  v_dot2c_f32_bf16 v51, v31, v11
  ds_read_b64_tr_b16 v[16:17], v8
  ds_read_b64_tr_b16 v[18:19], v9
  v_add_u32 v8, s54, v8
  v_add_u32 v9, s54, v9
  ds_read_b64_tr_b16 v[20:21], v8
  ds_read_b64_tr_b16 v[22:23], v9
  v_add_u32 v8, s54, v8
  v_add_u32 v9, s54, v9
  ds_read_b64_tr_b16 v[24:25], v8
  ds_read_b64_tr_b16 v[26:27], v9
  v_add_u32 v8, s54, v8
  v_add_u32 v9, s54, v9
  ds_read_b64_tr_b16 v[28:29], v8
  ds_read_b64_tr_b16 v[30:31], v9
  v_add_u32 v8, s54, v8
  v_add_u32 v9, s54, v9
  s_waitcnt lgkmcnt(14)
  v_dot2c_f32_bf16 v48, v32, v11
  v_dot2c_f32_bf16 v49, v33, v11
  v_dot2c_f32_bf16 v50, v34, v11
  v_dot2c_f32_bf16 v51, v35, v11
  s_waitcnt lgkmcnt(12)
  v_dot2c_f32_bf16 v48, v36, v11
  v_dot2c_f32_bf16 v49, v37, v11
  v_dot2c_f32_bf16 v50, v38, v11
  v_dot2c_f32_bf16 v51, v39, v11
  s_waitcnt lgkmcnt(10)
  v_dot2c_f32_bf16 v48, v40, v11
  v_dot2c_f32_bf16 v49, v41, v11
  v_dot2c_f32_bf16 v50, v42, v11
  v_dot2c_f32_bf16 v51, v43, v11
  s_waitcnt lgkmcnt(8)
  v_dot2c_f32_bf16 v48, v44, v11
  v_dot2c_f32_bf16 v49, v45, v11
  v_dot2c_f32_bf16 v50, v46, v11
  v_dot2c_f32_bf16 v51, v47, v11
  ds_read_b64_tr_b16 v[32:33], v8
  ds_read_b64_tr_b16 v[34:35], v9
  v_add_u32 v8, s54, v8
  v_add_u32 v9, s54, v9
  ds_read_b64_tr_b16 v[36:37], v8
  ds_read_b64_tr_b16 v[38:39], v9
  v_add_u32 v8, s54, v8
  v_add_u32 v9, s54, v9
  ds_read_b64_tr_b16 v[40:41], v8
  ds_read_b64_tr_b16 v[42:43], v9
  v_add_u32 v8, s54, v8
  v_add_u32 v9, s54, v9
  ds_read_b64_tr_b16 v[44:45], v8
  ds_read_b64_tr_b16 v[46:47], v9
  v_add_u32 v8, s54, v8
  v_add_u32 v9, s54, v9
  s_waitcnt lgkmcnt(14)
  v_dot2c_f32_bf16 v48, v16, v11
  v_dot2c_f32_bf16 v49, v17, v11
  v_dot2c_f32_bf16 v50, v18, v11
  v_dot2c_f32_bf16 v51, v19, v11
  s_waitcnt lgkmcnt(12)
  v_dot2c_f32_bf16 v48, v20, v11
  v_dot2c_f32_bf16 v49, v21, v11
  v_dot2c_f32_bf16 v50, v22, v11
  v_dot2c_f32_bf16 v51, v23, v11
  s_waitcnt lgkmcnt(10)
  v_dot2c_f32_bf16 v48, v24, v11
  v_dot2c_f32_bf16 v49, v25, v11
  v_dot2c_f32_bf16 v50, v26, v11
  v_dot2c_f32_bf16 v51, v27, v11
  s_waitcnt lgkmcnt(8)
  v_dot2c_f32_bf16 v48, v28, v11
  v_dot2c_f32_bf16 v49, v29, v11
  v_dot2c_f32_bf16 v50, v30, v11
  v_dot2c_f32_bf16 v51, v31, v11
  s_waitcnt lgkmcnt(6)
  v_dot2c_f32_bf16 v48, v32, v11
  v_dot2c_f32_bf16 v49, v33, v11
  v_dot2c_f32_bf16 v50, v34, v11
  v_dot2c_f32_bf16 v51, v35, v11
  s_waitcnt lgkmcnt(4)
  v_dot2c_f32_bf16 v48, v36, v11
  v_dot2c_f32_bf16 v49, v37, v11
  v_dot2c_f32_bf16 v50, v38, v11
  v_dot2c_f32_bf16 v51, v39, v11
  s_waitcnt lgkmcnt(2)
  v_dot2c_f32_bf16 v48, v40, v11
  v_dot2c_f32_bf16 v49, v41, v11
  v_dot2c_f32_bf16 v50, v42, v11
  v_dot2c_f32_bf16 v51, v43, v11
  s_waitcnt lgkmcnt(0)
  v_dot2c_f32_bf16 v48, v44, v11
  v_dot2c_f32_bf16 v49, v45, v11
  v_dot2c_f32_bf16 v50, v46, v11
  v_dot2c_f32_bf16 v51, v47, v11
  s_waitcnt vmcnt(0)
Lha_30:
  s_barrier
  s_sub_u32 s74, s42, 4
  s_lshl_b32 s75, s74, 14
  s_add_u32 s75, s75, 32768
  v_add_u32 v138, s75, v2
  s_lshl_b32 s75, s74, 13
  v_add_u32 v139, s75, v2
  ds_read_b128 v[144:147], v138 offset:0
  ds_read_b128 v[148:151], v138 offset:1024
  ds_read_b128 v[152:155], v138 offset:2048
  ds_read_b128 v[156:159], v138 offset:3072
  ds_read_b128 v[160:163], v138 offset:4096
  ds_read_b128 v[164:167], v138 offset:5120
  ds_read_b128 v[168:171], v138 offset:6144
  ds_read_b128 v[172:175], v138 offset:7168
  ds_read_b128 v[176:179], v138 offset:8192
  ds_read_b128 v[180:183], v138 offset:9216
  ds_read_b128 v[184:187], v138 offset:10240
  ds_read_b128 v[188:191], v138 offset:11264
  ds_read_b128 v[192:195], v138 offset:12288
  ds_read_b128 v[196:199], v138 offset:13312
  ds_read_b128 v[200:203], v138 offset:14336
  ds_read_b128 v[204:207], v138 offset:15360
  s_waitcnt lgkmcnt(0)
  s_cmp_eq_u32 s42, 4
  s_cbranch_scc1 Lhb_31
  s_cmp_eq_u32 s42, 7
  s_cbranch_scc1 Lhb_31
  ds_read_b64_tr_b16 v[16:17], v8
  ds_read_b64_tr_b16 v[18:19], v9
  v_add_u32 v8, s54, v8
  v_add_u32 v9, s54, v9
  ds_read_b64_tr_b16 v[20:21], v8
  ds_read_b64_tr_b16 v[22:23], v9
  v_add_u32 v8, s54, v8
  v_add_u32 v9, s54, v9
  ds_read_b64_tr_b16 v[24:25], v8
  ds_read_b64_tr_b16 v[26:27], v9
  v_add_u32 v8, s54, v8
  v_add_u32 v9, s54, v9
  ds_read_b64_tr_b16 v[28:29], v8
  ds_read_b64_tr_b16 v[30:31], v9
  v_add_u32 v8, s54, v8
  v_add_u32 v9, s54, v9
  ds_read_b64_tr_b16 v[32:33], v8
  ds_read_b64_tr_b16 v[34:35], v9
  v_add_u32 v8, s54, v8
  v_add_u32 v9, s54, v9
  ds_read_b64_tr_b16 v[36:37], v8
  ds_read_b64_tr_b16 v[38:39], v9
  v_add_u32 v8, s54, v8
  v_add_u32 v9, s54, v9
  ds_read_b64_tr_b16 v[40:41], v8
  ds_read_b64_tr_b16 v[42:43], v9
  v_add_u32 v8, s54, v8
  v_add_u32 v9, s54, v9
  ds_read_b64_tr_b16 v[44:45], v8
  ds_read_b64_tr_b16 v[46:47], v9
  v_add_u32 v8, s54, v8
  v_add_u32 v9, s54, v9
  s_waitcnt lgkmcnt(14)
  v_dot2c_f32_bf16 v48, v16, v11
  v_dot2c_f32_bf16 v49, v17, v11
  v_dot2c_f32_bf16 v50, v18, v11
  v_dot2c_f32_bf16 v51, v19, v11
  s_waitcnt lgkmcnt(12)
  v_dot2c_f32_bf16 v48, v20, v11
  v_dot2c_f32_bf16 v49, v21, v11
  v_dot2c_f32_bf16 v50, v22, v11
  v_dot2c_f32_bf16 v51, v23, v11
  s_waitcnt lgkmcnt(10)
  v_dot2c_f32_bf16 v48, v24, v11
  v_dot2c_f32_bf16 v49, v25, v11
  v_dot2c_f32_bf16 v50, v26, v11
  v_dot2c_f32_bf16 v51, v27, v11
  s_waitcnt lgkmcnt(8)
  v_dot2c_f32_bf16 v48, v28, v11
  v_dot2c_f32_bf16 v49, v29, v11
  v_dot2c_f32_bf16 v50, v30, v11
  v_dot2c_f32_bf16 v51, v31, v11
  ds_read_b64_tr_b16 v[16:17], v8
  ds_read_b64_tr_b16 v[18:19], v9
  v_add_u32 v8, s54, v8
  v_add_u32 v9, s54, v9
  ds_read_b64_tr_b16 v[20:21], v8
  ds_read_b64_tr_b16 v[22:23], v9
  v_add_u32 v8, s54, v8
  v_add_u32 v9, s54, v9
  ds_read_b64_tr_b16 v[24:25], v8
  ds_read_b64_tr_b16 v[26:27], v9
  v_add_u32 v8, s54, v8
  v_add_u32 v9, s54, v9
  ds_read_b64_tr_b16 v[28:29], v8
  ds_read_b64_tr_b16 v[30:31], v9
  v_add_u32 v8, s54, v8
  v_add_u32 v9, s54, v9
  s_waitcnt lgkmcnt(14)
  v_dot2c_f32_bf16 v48, v32, v11
  v_dot2c_f32_bf16 v49, v33, v11
  v_dot2c_f32_bf16 v50, v34, v11
  v_dot2c_f32_bf16 v51, v35, v11
  s_waitcnt lgkmcnt(12)
  v_dot2c_f32_bf16 v48, v36, v11
  v_dot2c_f32_bf16 v49, v37, v11
  v_dot2c_f32_bf16 v50, v38, v11
  v_dot2c_f32_bf16 v51, v39, v11
  s_waitcnt lgkmcnt(10)
  v_dot2c_f32_bf16 v48, v40, v11
  v_dot2c_f32_bf16 v49, v41, v11
  v_dot2c_f32_bf16 v50, v42, v11
  v_dot2c_f32_bf16 v51, v43, v11
  s_waitcnt lgkmcnt(8)
  v_dot2c_f32_bf16 v48, v44, v11
  v_dot2c_f32_bf16 v49, v45, v11
  v_dot2c_f32_bf16 v50, v46, v11
  v_dot2c_f32_bf16 v51, v47, v11
  ds_read_b64_tr_b16 v[32:33], v8
  ds_read_b64_tr_b16 v[34:35], v9
  v_add_u32 v8, s54, v8
  v_add_u32 v9, s54, v9
  ds_read_b64_tr_b16 v[36:37], v8
  ds_read_b64_tr_b16 v[38:39], v9
  v_add_u32 v8, s54, v8
  v_add_u32 v9, s54, v9
  ds_read_b64_tr_b16 v[40:41], v8
  ds_read_b64_tr_b16 v[42:43], v9
  v_add_u32 v8, s54, v8
  v_add_u32 v9, s54, v9
  ds_read_b64_tr_b16 v[44:45], v8
  ds_read_b64_tr_b16 v[46:47], v9
  v_add_u32 v8, s54, v8
  v_add_u32 v9, s54, v9
  s_waitcnt lgkmcnt(14)
  v_dot2c_f32_bf16 v48, v16, v11
  v_dot2c_f32_bf16 v49, v17, v11
  v_dot2c_f32_bf16 v50, v18, v11
  v_dot2c_f32_bf16 v51, v19, v11
  s_waitcnt lgkmcnt(12)
  v_dot2c_f32_bf16 v48, v20, v11
  v_dot2c_f32_bf16 v49, v21, v11
  v_dot2c_f32_bf16 v50, v22, v11
  v_dot2c_f32_bf16 v51, v23, v11
  s_waitcnt lgkmcnt(10)
  v_dot2c_f32_bf16 v48, v24, v11
  v_dot2c_f32_bf16 v49, v25, v11
  v_dot2c_f32_bf16 v50, v26, v11
  v_dot2c_f32_bf16 v51, v27, v11
  s_waitcnt lgkmcnt(8)
  v_dot2c_f32_bf16 v48, v28, v11
  v_dot2c_f32_bf16 v49, v29, v11
  v_dot2c_f32_bf16 v50, v30, v11
  v_dot2c_f32_bf16 v51, v31, v11
  s_waitcnt lgkmcnt(6)
  v_dot2c_f32_bf16 v48, v32, v11
  v_dot2c_f32_bf16 v49, v33, v11
  v_dot2c_f32_bf16 v50, v34, v11
  v_dot2c_f32_bf16 v51, v35, v11
  s_waitcnt lgkmcnt(4)
  v_dot2c_f32_bf16 v48, v36, v11
  v_dot2c_f32_bf16 v49, v37, v11
  v_dot2c_f32_bf16 v50, v38, v11
  v_dot2c_f32_bf16 v51, v39, v11
  s_waitcnt lgkmcnt(2)
  v_dot2c_f32_bf16 v48, v40, v11
  v_dot2c_f32_bf16 v49, v41, v11
  v_dot2c_f32_bf16 v50, v42, v11
  v_dot2c_f32_bf16 v51, v43, v11
  s_waitcnt lgkmcnt(0)
  v_dot2c_f32_bf16 v48, v44, v11
  v_dot2c_f32_bf16 v49, v45, v11
  v_dot2c_f32_bf16 v50, v46, v11
  v_dot2c_f32_bf16 v51, v47, v11
  s_nop 0
  v_add_f32 v48, v48, v49
  s_nop 0
  v_add_f32 v50, v50, v51
  v_add_f32 v9, v48, v50
  v_mov_b32 v10, v9
  s_nop 1
  v_permlane32_swap_b32 v9, v10
  v_add_f32 v240, v9, v10
  s_sub_u32 s60, s42, 4
  s_cmp_eq_u32 s42, 7
  s_cselect_b32 s60, 0, s60
  s_lshl_b32 s50, s60, 7
  s_add_u32 s50, s50, 162816
  v_and_b32 v12, 31, v1
  v_lshlrev_b32 v12, 2, v12
  v_add_u32 v12, s50, v12
  ds_write_b32 v12, v240
  s_waitcnt lgkmcnt(0)
Lhb_31:
  s_cmp_eq_u32 s42, 7
  s_cbranch_scc0 Law3_40
  s_mov_b32 s79, 64
  v_mov_b32 v14, 163836
Law_38:
  ds_read_b32 v15, v14
  s_sub_u32 s79, s79, 1
  s_cbranch_scc1 Law2_39
  s_waitcnt lgkmcnt(0)
  v_readfirstlane_b32 s78, v15
  s_nop 0
  s_cmp_eq_u32 s78, 0
  s_cbranch_scc1 Law_38
Law2_39:
  s_waitcnt lgkmcnt(0)
  v_lshrrev_b32 v14, 2, v1
  v_mul_u32_u24 v14, 3072, v14
  v_and_b32 v15, 3, v1
  v_lshl_add_u32 v8, v15, 4, v14
  s_lshr_b32 s51, s41, 1
  s_lshl_b32 s51, s51, 6
  s_mov_b32 s52, 0
  s_and_b32 s53, s41, 1
  s_lshl_b32 s53, s53, 4
  s_mov_b32 s73, s53
  s_mul_i32 s74, s73, 49152
  s_mul_i32 s75, s73, 1024
  s_add_u32 s74, s74, s51
  s_add_u32 s75, s75, s52
  s_mov_b32 m0, s75
  s_add_u32 s73, s73, 1
  buffer_load_dwordx4 v8, s[8:11], s74 offen lds
  s_cmp_eq_u32 s73, 32
  s_cselect_b32 s73, 0, s73
  s_mul_i32 s74, s73, 49152
  s_mul_i32 s75, s73, 1024
  s_add_u32 s74, s74, s51
  s_add_u32 s75, s75, s52
  s_mov_b32 m0, s75
  s_add_u32 s73, s73, 1
  buffer_load_dwordx4 v8, s[8:11], s74 offen lds
  s_cmp_eq_u32 s73, 32
  s_cselect_b32 s73, 0, s73
  s_mul_i32 s74, s73, 49152
  s_mul_i32 s75, s73, 1024
  s_add_u32 s74, s74, s51
  s_add_u32 s75, s75, s52
  s_mov_b32 m0, s75
  s_add_u32 s73, s73, 1
  buffer_load_dwordx4 v8, s[8:11], s74 offen lds
  s_cmp_eq_u32 s73, 32
  s_cselect_b32 s73, 0, s73
  s_mul_i32 s74, s73, 49152
  s_mul_i32 s75, s73, 1024
  s_add_u32 s74, s74, s51
  s_add_u32 s75, s75, s52
  s_mov_b32 m0, s75
  s_add_u32 s73, s73, 1
  buffer_load_dwordx4 v8, s[8:11], s74 offen lds
  s_cmp_eq_u32 s73, 32
  s_cselect_b32 s73, 0, s73
  s_mul_i32 s74, s73, 49152
  s_mul_i32 s75, s73, 1024
  s_add_u32 s74, s74, s51
  s_add_u32 s75, s75, s52
  s_mov_b32 m0, s75
  s_add_u32 s73, s73, 1
  buffer_load_dwordx4 v8, s[8:11], s74 offen lds
  s_cmp_eq_u32 s73, 32
  s_cselect_b32 s73, 0, s73
  s_mul_i32 s74, s73, 49152
  s_mul_i32 s75, s73, 1024
  s_add_u32 s74, s74, s51
  s_add_u32 s75, s75, s52
  s_mov_b32 m0, s75
  s_add_u32 s73, s73, 1
  buffer_load_dwordx4 v8, s[8:11], s74 offen lds
  s_cmp_eq_u32 s73, 32
  s_cselect_b32 s73, 0, s73
  s_mul_i32 s74, s73, 49152
  s_mul_i32 s75, s73, 1024
  s_add_u32 s74, s74, s51
  s_add_u32 s75, s75, s52
  s_mov_b32 m0, s75
  s_add_u32 s73, s73, 1
  buffer_load_dwordx4 v8, s[8:11], s74 offen lds
  s_cmp_eq_u32 s73, 32
  s_cselect_b32 s73, 0, s73
  s_mul_i32 s74, s73, 49152
  s_mul_i32 s75, s73, 1024
  s_add_u32 s74, s74, s51
  s_add_u32 s75, s75, s52
  s_mov_b32 m0, s75
  s_add_u32 s73, s73, 1
  buffer_load_dwordx4 v8, s[8:11], s74 offen lds
  s_cmp_eq_u32 s73, 32
  s_cselect_b32 s73, 0, s73
  s_mul_i32 s74, s73, 49152
  s_mul_i32 s75, s73, 1024
  s_add_u32 s74, s74, s51
  s_add_u32 s75, s75, s52
  s_mov_b32 m0, s75
  s_add_u32 s73, s73, 1
  buffer_load_dwordx4 v8, s[8:11], s74 offen lds
  s_cmp_eq_u32 s73, 32
  s_cselect_b32 s73, 0, s73
  s_mul_i32 s74, s73, 49152
  s_mul_i32 s75, s73, 1024
  s_add_u32 s74, s74, s51
  s_add_u32 s75, s75, s52
  s_mov_b32 m0, s75
  s_add_u32 s73, s73, 1
  buffer_load_dwordx4 v8, s[8:11], s74 offen lds
  s_cmp_eq_u32 s73, 32
  s_cselect_b32 s73, 0, s73
  s_mul_i32 s74, s73, 49152
  s_mul_i32 s75, s73, 1024
  s_add_u32 s74, s74, s51
  s_add_u32 s75, s75, s52
  s_mov_b32 m0, s75
  s_add_u32 s73, s73, 1
  buffer_load_dwordx4 v8, s[8:11], s74 offen lds
  s_cmp_eq_u32 s73, 32
  s_cselect_b32 s73, 0, s73
  s_mul_i32 s74, s73, 49152
  s_mul_i32 s75, s73, 1024
  s_add_u32 s74, s74, s51
  s_add_u32 s75, s75, s52
  s_mov_b32 m0, s75
  s_add_u32 s73, s73, 1
  buffer_load_dwordx4 v8, s[8:11], s74 offen lds
  s_cmp_eq_u32 s73, 32
  s_cselect_b32 s73, 0, s73
  s_mul_i32 s74, s73, 49152
  s_mul_i32 s75, s73, 1024
  s_add_u32 s74, s74, s51
  s_add_u32 s75, s75, s52
  s_mov_b32 m0, s75
  s_add_u32 s73, s73, 1
  buffer_load_dwordx4 v8, s[8:11], s74 offen lds
  s_cmp_eq_u32 s73, 32
  s_cselect_b32 s73, 0, s73
  s_mul_i32 s74, s73, 49152
  s_mul_i32 s75, s73, 1024
  s_add_u32 s74, s74, s51
  s_add_u32 s75, s75, s52
  s_mov_b32 m0, s75
  s_add_u32 s73, s73, 1
  buffer_load_dwordx4 v8, s[8:11], s74 offen lds
  s_cmp_eq_u32 s73, 32
  s_cselect_b32 s73, 0, s73
  s_mul_i32 s74, s73, 49152
  s_mul_i32 s75, s73, 1024
  s_add_u32 s74, s74, s51
  s_add_u32 s75, s75, s52
  s_mov_b32 m0, s75
  s_add_u32 s73, s73, 1
  buffer_load_dwordx4 v8, s[8:11], s74 offen lds
  s_cmp_eq_u32 s73, 32
  s_cselect_b32 s73, 0, s73
  s_mul_i32 s74, s73, 49152
  s_mul_i32 s75, s73, 1024
  s_add_u32 s74, s74, s51
  s_add_u32 s75, s75, s52
  s_mov_b32 m0, s75
  s_add_u32 s73, s73, 1
  buffer_load_dwordx4 v8, s[8:11], s74 offen lds
  s_cmp_eq_u32 s73, 32
  s_cselect_b32 s73, 0, s73
  s_mul_i32 s74, s73, 49152
  s_mul_i32 s75, s73, 1024
  s_add_u32 s74, s74, s51
  s_add_u32 s75, s75, s52
  s_mov_b32 m0, s75
  s_add_u32 s73, s73, 1
  buffer_load_dwordx4 v8, s[8:11], s74 offen lds
  s_cmp_eq_u32 s73, 32
  s_cselect_b32 s73, 0, s73
  s_mul_i32 s74, s73, 49152
  s_mul_i32 s75, s73, 1024
  s_add_u32 s74, s74, s51
  s_add_u32 s75, s75, s52
  s_mov_b32 m0, s75
  s_add_u32 s73, s73, 1
  buffer_load_dwordx4 v8, s[8:11], s74 offen lds
  s_cmp_eq_u32 s73, 32
  s_cselect_b32 s73, 0, s73
  s_mul_i32 s74, s73, 49152
  s_mul_i32 s75, s73, 1024
  s_add_u32 s74, s74, s51
  s_add_u32 s75, s75, s52
  s_mov_b32 m0, s75
  s_add_u32 s73, s73, 1
  buffer_load_dwordx4 v8, s[8:11], s74 offen lds
  s_cmp_eq_u32 s73, 32
  s_cselect_b32 s73, 0, s73
  s_mul_i32 s74, s73, 49152
  s_mul_i32 s75, s73, 1024
  s_add_u32 s74, s74, s51
  s_add_u32 s75, s75, s52
  s_mov_b32 m0, s75
  s_add_u32 s73, s73, 1
  buffer_load_dwordx4 v8, s[8:11], s74 offen lds
  s_cmp_eq_u32 s73, 32
  s_cselect_b32 s73, 0, s73
  s_mul_i32 s74, s73, 49152
  s_mul_i32 s75, s73, 1024
  s_add_u32 s74, s74, s51
  s_add_u32 s75, s75, s52
  s_mov_b32 m0, s75
  s_add_u32 s73, s73, 1
  buffer_load_dwordx4 v8, s[8:11], s74 offen lds
  s_cmp_eq_u32 s73, 32
  s_cselect_b32 s73, 0, s73
  s_mul_i32 s74, s73, 49152
  s_mul_i32 s75, s73, 1024
  s_add_u32 s74, s74, s51
  s_add_u32 s75, s75, s52
  s_mov_b32 m0, s75
  s_add_u32 s73, s73, 1
  buffer_load_dwordx4 v8, s[8:11], s74 offen lds
  s_cmp_eq_u32 s73, 32
  s_cselect_b32 s73, 0, s73
  s_mul_i32 s74, s73, 49152
  s_mul_i32 s75, s73, 1024
  s_add_u32 s74, s74, s51
  s_add_u32 s75, s75, s52
  s_mov_b32 m0, s75
  s_add_u32 s73, s73, 1
  buffer_load_dwordx4 v8, s[8:11], s74 offen lds
  s_cmp_eq_u32 s73, 32
  s_cselect_b32 s73, 0, s73
  s_mul_i32 s74, s73, 49152
  s_mul_i32 s75, s73, 1024
  s_add_u32 s74, s74, s51
  s_add_u32 s75, s75, s52
  s_mov_b32 m0, s75
  s_add_u32 s73, s73, 1
  buffer_load_dwordx4 v8, s[8:11], s74 offen lds
  s_cmp_eq_u32 s73, 32
  s_cselect_b32 s73, 0, s73
  s_mul_i32 s74, s73, 49152
  s_mul_i32 s75, s73, 1024
  s_add_u32 s74, s74, s51
  s_add_u32 s75, s75, s52
  s_mov_b32 m0, s75
  s_add_u32 s73, s73, 1
  buffer_load_dwordx4 v8, s[8:11], s74 offen lds
  s_cmp_eq_u32 s73, 32
  s_cselect_b32 s73, 0, s73
  s_mul_i32 s74, s73, 49152
  s_mul_i32 s75, s73, 1024
  s_add_u32 s74, s74, s51
  s_add_u32 s75, s75, s52
  s_mov_b32 m0, s75
  s_add_u32 s73, s73, 1
  buffer_load_dwordx4 v8, s[8:11], s74 offen lds
  s_cmp_eq_u32 s73, 32
  s_cselect_b32 s73, 0, s73
  s_mul_i32 s74, s73, 49152
  s_mul_i32 s75, s73, 1024
  s_add_u32 s74, s74, s51
  s_add_u32 s75, s75, s52
  s_mov_b32 m0, s75
  s_add_u32 s73, s73, 1
  buffer_load_dwordx4 v8, s[8:11], s74 offen lds
  s_cmp_eq_u32 s73, 32
  s_cselect_b32 s73, 0, s73
  s_mul_i32 s74, s73, 49152
  s_mul_i32 s75, s73, 1024
  s_add_u32 s74, s74, s51
  s_add_u32 s75, s75, s52
  s_mov_b32 m0, s75
  s_add_u32 s73, s73, 1
  buffer_load_dwordx4 v8, s[8:11], s74 offen lds
  s_cmp_eq_u32 s73, 32
  s_cselect_b32 s73, 0, s73
  s_mul_i32 s74, s73, 49152
  s_mul_i32 s75, s73, 1024
  s_add_u32 s74, s74, s51
  s_add_u32 s75, s75, s52
  s_mov_b32 m0, s75
  s_add_u32 s73, s73, 1
  buffer_load_dwordx4 v8, s[8:11], s74 offen lds
  s_cmp_eq_u32 s73, 32
  s_cselect_b32 s73, 0, s73
  s_mul_i32 s74, s73, 49152
  s_mul_i32 s75, s73, 1024
  s_add_u32 s74, s74, s51
  s_add_u32 s75, s75, s52
  s_mov_b32 m0, s75
  s_add_u32 s73, s73, 1
  buffer_load_dwordx4 v8, s[8:11], s74 offen lds
  s_cmp_eq_u32 s73, 32
  s_cselect_b32 s73, 0, s73
  s_mul_i32 s74, s73, 49152
  s_mul_i32 s75, s73, 1024
  s_add_u32 s74, s74, s51
  s_add_u32 s75, s75, s52
  s_mov_b32 m0, s75
  s_add_u32 s73, s73, 1
  buffer_load_dwordx4 v8, s[8:11], s74 offen lds
  s_cmp_eq_u32 s73, 32
  s_cselect_b32 s73, 0, s73
  s_mul_i32 s74, s73, 49152
  s_mul_i32 s75, s73, 1024
  s_add_u32 s74, s74, s51
  s_add_u32 s75, s75, s52
  s_mov_b32 m0, s75
  s_add_u32 s73, s73, 1
  buffer_load_dwordx4 v8, s[8:11], s74 offen lds
Law3_40:
  s_barrier
  s_cmp_eq_u32 s42, 7
  s_cbranch_scc0 Lhe_35
  s_waitcnt vmcnt(0)
Lhe_35:
  s_barrier
  v_lshrrev_b32 v14, 3, v1
  v_mul_u32_u24 v14, 1024, v14
  v_bfe_u32 v15, v1, 4, 1
  v_lshlrev_b32 v15, 2, v15
  v_xor_b32 v15, v15, v1
  v_and_b32 v15, 7, v15
  v_lshl_add_u32 v8, v15, 4, v14
  s_sub_u32 s50, s42, 4
  s_and_b32 s51, s41, 7
  s_lshl_b32 s51, s51, 7
  s_lshl_b32 s83, s50, 13
  s_add_u32 s51, s51, s83
  s_lshl_b32 s52, s50, 10
  s_add_u32 s52, s52, 98304
  s_lshr_b32 s53, s41, 3
  s_mul_i32 s53, s53, 6
  s_lshr_b32 s53, s53, 2
  s_mov_b32 s73, s53
  s_mul_i32 s74, s73, 32768
  s_mul_i32 s75, s73, 4096
  s_add_u32 s74, s74, s51
  s_add_u32 s75, s75, s52
  s_mov_b32 m0, s75
  s_add_u32 s73, s73, 1
  buffer_load_dwordx4 v8, s[12:15], s74 offen lds
  s_cmp_eq_u32 s73, 6
  s_cselect_b32 s73, 0, s73
  s_mul_i32 s74, s73, 32768
  s_mul_i32 s75, s73, 4096
  s_add_u32 s74, s74, s51
  s_add_u32 s75, s75, s52
  s_mov_b32 m0, s75
  s_add_u32 s73, s73, 1
  buffer_load_dwordx4 v8, s[12:15], s74 offen lds
  s_cmp_eq_u32 s73, 6
  s_cselect_b32 s73, 0, s73
  s_mul_i32 s74, s73, 32768
  s_mul_i32 s75, s73, 4096
  s_add_u32 s74, s74, s51
  s_add_u32 s75, s75, s52
  s_mov_b32 m0, s75
  s_add_u32 s73, s73, 1
  buffer_load_dwordx4 v8, s[12:15], s74 offen lds
  s_cmp_eq_u32 s73, 6
  s_cselect_b32 s73, 0, s73
  s_mul_i32 s74, s73, 32768
  s_mul_i32 s75, s73, 4096
  s_add_u32 s74, s74, s51
  s_add_u32 s75, s75, s52
  s_mov_b32 m0, s75
  s_add_u32 s73, s73, 1
  buffer_load_dwordx4 v8, s[12:15], s74 offen lds
  s_cmp_eq_u32 s73, 6
  s_cselect_b32 s73, 0, s73
  s_mul_i32 s74, s73, 32768
  s_mul_i32 s75, s73, 4096
  s_add_u32 s74, s74, s51
  s_add_u32 s75, s75, s52
  s_mov_b32 m0, s75
  s_add_u32 s73, s73, 1
  buffer_load_dwordx4 v8, s[12:15], s74 offen lds
  s_cmp_eq_u32 s73, 6
  s_cselect_b32 s73, 0, s73
  s_mul_i32 s74, s73, 32768
  s_mul_i32 s75, s73, 4096
  s_add_u32 s74, s74, s51
  s_add_u32 s75, s75, s52
  s_mov_b32 m0, s75
  s_add_u32 s73, s73, 1
  buffer_load_dwordx4 v8, s[12:15], s74 offen lds
  s_sub_u32 s50, s42, 4
  s_lshl_b32 s51, s50, 13
  v_add_u32 v8, s51, v4
  v_add_u32 v9, 512, v8
  s_mov_b32 s54, 1024
  v_mov_b32 v48, 0
  v_mov_b32 v49, 0
  v_mov_b32 v50, 0
  v_mov_b32 v51, 0
  v_mov_b32 v11, 0x3f803f80
  ds_read_b64_tr_b16 v[16:17], v8
  ds_read_b64_tr_b16 v[18:19], v9
  v_add_u32 v8, s54, v8
  v_add_u32 v9, s54, v9
  ds_read_b64_tr_b16 v[20:21], v8
  ds_read_b64_tr_b16 v[22:23], v9
  v_add_u32 v8, s54, v8
  v_add_u32 v9, s54, v9
  ds_read_b64_tr_b16 v[24:25], v8
  ds_read_b64_tr_b16 v[26:27], v9
  v_add_u32 v8, s54, v8
  v_add_u32 v9, s54, v9
  ds_read_b64_tr_b16 v[28:29], v8
  ds_read_b64_tr_b16 v[30:31], v9
  v_add_u32 v8, s54, v8
  v_add_u32 v9, s54, v9
  ds_read_b64_tr_b16 v[32:33], v8
  ds_read_b64_tr_b16 v[34:35], v9
  v_add_u32 v8, s54, v8
  v_add_u32 v9, s54, v9
  ds_read_b64_tr_b16 v[36:37], v8
  ds_read_b64_tr_b16 v[38:39], v9
  v_add_u32 v8, s54, v8
  v_add_u32 v9, s54, v9
  ds_read_b64_tr_b16 v[40:41], v8
  ds_read_b64_tr_b16 v[42:43], v9
  v_add_u32 v8, s54, v8
  v_add_u32 v9, s54, v9
  ds_read_b64_tr_b16 v[44:45], v8
  ds_read_b64_tr_b16 v[46:47], v9
  v_add_u32 v8, s54, v8
  v_add_u32 v9, s54, v9
  s_waitcnt lgkmcnt(14)
  v_dot2c_f32_bf16 v48, v16, v11
  v_dot2c_f32_bf16 v49, v17, v11
  v_dot2c_f32_bf16 v50, v18, v11
  v_dot2c_f32_bf16 v51, v19, v11
  s_waitcnt lgkmcnt(12)
  v_dot2c_f32_bf16 v48, v20, v11
  v_dot2c_f32_bf16 v49, v21, v11
  v_dot2c_f32_bf16 v50, v22, v11
  v_dot2c_f32_bf16 v51, v23, v11
  s_waitcnt lgkmcnt(10)
  v_dot2c_f32_bf16 v48, v24, v11
  v_dot2c_f32_bf16 v49, v25, v11
  v_dot2c_f32_bf16 v50, v26, v11
  v_dot2c_f32_bf16 v51, v27, v11
  s_waitcnt lgkmcnt(8)
  v_dot2c_f32_bf16 v48, v28, v11
  v_dot2c_f32_bf16 v49, v29, v11
  v_dot2c_f32_bf16 v50, v30, v11
  v_dot2c_f32_bf16 v51, v31, v11
  s_waitcnt lgkmcnt(6)
  v_dot2c_f32_bf16 v48, v32, v11
  v_dot2c_f32_bf16 v49, v33, v11
  v_dot2c_f32_bf16 v50, v34, v11
  v_dot2c_f32_bf16 v51, v35, v11
  s_waitcnt lgkmcnt(4)
  v_dot2c_f32_bf16 v48, v36, v11
  v_dot2c_f32_bf16 v49, v37, v11
  v_dot2c_f32_bf16 v50, v38, v11
  v_dot2c_f32_bf16 v51, v39, v11
  s_waitcnt lgkmcnt(2)
  v_dot2c_f32_bf16 v48, v40, v11
  v_dot2c_f32_bf16 v49, v41, v11
  v_dot2c_f32_bf16 v50, v42, v11
  v_dot2c_f32_bf16 v51, v43, v11
  s_waitcnt lgkmcnt(0)
  v_dot2c_f32_bf16 v48, v44, v11
  v_dot2c_f32_bf16 v49, v45, v11
  v_dot2c_f32_bf16 v50, v46, v11
  v_dot2c_f32_bf16 v51, v47, v11
  s_nop 0
  v_add_f32 v48, v48, v49
  s_nop 0
  v_add_f32 v50, v50, v51
  v_add_f32 v9, v48, v50
  v_mov_b32 v10, v9
  s_nop 1
  v_permlane32_swap_b32 v9, v10
  v_add_f32 v9, v9, v10
  v_and_b32 v12, 31, v1
  v_lshlrev_b32 v12, 2, v12
  s_lshl_b32 s51, s50, 7
  s_add_u32 s51, s51, 163200
  v_add_u32 v10, s51, v12
  ds_write_b32 v10, v9
  s_waitcnt lgkmcnt(0)
  s_barrier
  s_cmp_eq_u32 s42, 7
  s_cbranch_scc0 Lhf_36
  v_add_u32 v10, 163200, v12
  ds_read_b32 v48, v10 offset:0
  ds_read_b32 v49, v10 offset:128
  ds_read_b32 v50, v10 offset:256
  ds_read_b32 v51, v10 offset:384
  s_waitcnt lgkmcnt(0)
  v_add_f32 v48, v48, v49
  v_add_f32 v50, v50, v51
  v_add_f32 v240, v48, v50
  s_sub_u32 s60, s42, 4
  s_cmp_eq_u32 s42, 7
  s_cselect_b32 s60, 0, s60
  s_lshl_b32 s50, s60, 7
  s_add_u32 s50, s50, 162816
  v_and_b32 v12, 31, v1
  v_lshlrev_b32 v12, 2, v12
  v_add_u32 v12, s50, v12
  ds_write_b32 v12, v240
  s_waitcnt lgkmcnt(0)
Lhf_36:
  s_sub_u32 s74, s42, 4
  s_lshl_b32 s75, s74, 14
  s_add_u32 s75, s75, 32768
  v_add_u32 v138, s75, v2
  s_lshl_b32 s75, s74, 13
  v_add_u32 v139, s75, v2
  ds_read_b128 v[208:211], v139 offset:0
  ds_read_b128 v[212:215], v139 offset:1024
  ds_read_b128 v[216:219], v139 offset:2048
  ds_read_b128 v[220:223], v139 offset:3072
  ds_read_b128 v[224:227], v139 offset:4096
  ds_read_b128 v[228:231], v139 offset:5120
  ds_read_b128 v[232:235], v139 offset:6144
  ds_read_b128 v[236:239], v139 offset:7168
  s_waitcnt lgkmcnt(0)
  s_barrier
  s_branch Lh4_33
Lhl1_29:
  s_barrier
  s_cmp_eq_u32 s42, 4
  s_cbranch_scc1 Lhg_37
  s_sub_u32 s60, s42, 4
  s_cmp_eq_u32 s42, 7
  s_cselect_b32 s60, 0, s60
  s_lshl_b32 s50, s60, 7
  s_add_u32 s50, s50, 162816
  v_and_b32 v12, 31, v1
  v_lshlrev_b32 v12, 2, v12
  v_add_u32 v12, s50, v12
  ds_write_b32 v12, v240
  s_waitcnt lgkmcnt(0)
Lhg_37:
  s_barrier
Lh4_33:
L_qkv_d:
  s_lshl_b32 s82, s40, 3
  s_add_u32 s82, s82, s42
  s_mul_i32 s54, s82, 98304
  s_mov_b32 s54, s54
  s_lshl_b32 s83, s41, 10
  s_add_u32 s54, s54, s83
  s_add_u32 s54, s54, 2097152
  s_lshr_b32 s52, s41, 1
  s_lshl_b32 s53, s40, 7
  s_lshl_b32 s83, s52, 3
  s_add_u32 s53, s53, s83
  s_add_u32 s53, s53, s42
  s_lshl_b32 s53, s53, 2
  s_add_u32 s53, s53, s46
  s_add_u32 s53, s53, 13893632
  s_mov_b32 s55, s54
  s_cmp_lt_u32 s42, 4
  s_cbranch_scc1 Lam_41
  s_sub_u32 s56, s42, 4
  s_lshr_b32 s57, s41, 2
  s_lshl_b32 s58, s57, 1
  s_lshl_b32 s57, s40, 7
  s_lshl_b32 s83, s58, 3
  s_add_u32 s57, s57, s83
  s_lshl_b32 s58, s57, 2
  s_add_u32 s58, s58, s46
  s_add_u32 s58, s58, 13926400
  s_mov_b32 s59, s57
  s_add_u32 s59, s59, s56
  s_lshl_b32 s59, s59, 7
  s_add_u32 s59, s59, s46
  s_add_u32 s59, s59, 13746176
  s_lshl_b32 s62, s40, 3
  s_add_u32 s62, s62, s56
  s_lshl_b32 s63, s62, 15
  s_lshl_b32 s83, s41, 10
  s_add_u32 s63, s63, s83
  s_add_u32 s63, s63, s46
  s_add_u32 s63, s63, 9175040
  s_mul_i32 s62, s62, 98304
  s_mov_b32 s62, s62
  s_lshl_b32 s83, s41, 10
  s_add_u32 s62, s62, s83
  s_add_u32 s62, s62, 2097152
  s_lshl_b32 s64, s56, 10
  v_and_b32 v12, 15, v1
  v_lshlrev_b32 v12, 2, v12
  v_add_u32 v12, s58, v12
  v_and_b32 v13, 3, v1
  v_lshlrev_b32 v13, 9, v13
  v_add_u32 v13, s59, v13
  v_bfe_u32 v11, v1, 4, 1
  s_cmp_eq_u32 s40, 0
  s_cselect_b32 s60, 0, 1
  v_and_b32 v11, s60, v11
  v_cmp_eq_u32 vcc, 1, v11
  s_nop 1
  v_cndmask_b32 v12, v12, v13, vcc
  v_mov_b32 v13, s43
  v_mov_b32 v11, s44
  v_cndmask_b32 v13, v13, v11, vcc
  v_cmp_lt_u32 vcc, 31, v1
  v_mov_b32 v11, s53
  s_nop 0
  v_cndmask_b32 v12, v12, v11, vcc
  v_mov_b32 v11, s43
  v_cndmask_b32 v13, v13, v11, vcc
  s_cmp_lg_u32 s40, 0
  s_cbranch_scc1 Lzf_47
  v_mov_b32 v20, 0
  v_mov_b32 v21, 0
  v_mov_b32 v22, 0
  v_mov_b32 v23, 0
  v_add_u32 v11, s64, v2
  v_add_u32 v10, 63488, v11
  ds_write_b128 v10, v[20:23]
  v_add_u32 v10, 67584, v11
  ds_write_b128 v10, v[20:23]
  v_add_u32 v10, 79872, v11
  ds_write_b128 v10, v[20:23]
  v_add_u32 v10, 83968, v11
  ds_write_b128 v10, v[20:23]
Lzf_47:
  s_cmp_eq_u32 s40, 0
  s_cselect_b32 s65, 1, 0
  s_mov_b32 s79, 262144
  s_mov_b32 s78, 0
  buffer_load_dword v15, v12, s[24:27], s78 offen sc1
  v_mov_b32 v16, 0x3f803f80
  v_mov_b32 v17, v16
  v_mov_b32 v18, v16
  v_mov_b32 v19, v16
  v_add_u32 v9, 96256, v2
  ds_write_b128 v9, v[16:19]
  v_and_b32 v8, 31, v1
  v_lshrrev_b32 v9, 2, v5
  v_sub_u32 v8, v8, v9
  v_mov_b32 v10, 0xf149f2ca
  v_subrev_u32 v9, 0, v8
  v_ashrrev_i32 v9, 31, v9
  v_and_b32 v96, v10, v9
  v_xor_b32 v112, v10, v96
  v_subrev_u32 v9, 1, v8
  v_ashrrev_i32 v9, 31, v9
  v_and_b32 v97, v10, v9
  v_xor_b32 v113, v10, v97
  v_subrev_u32 v9, 2, v8
  v_ashrrev_i32 v9, 31, v9
  v_and_b32 v98, v10, v9
  v_xor_b32 v114, v10, v98
  v_subrev_u32 v9, 3, v8
  v_ashrrev_i32 v9, 31, v9
  v_and_b32 v99, v10, v9
  v_xor_b32 v115, v10, v99
  v_subrev_u32 v9, 8, v8
  v_ashrrev_i32 v9, 31, v9
  v_and_b32 v100, v10, v9
  v_xor_b32 v116, v10, v100
  v_subrev_u32 v9, 9, v8
  v_ashrrev_i32 v9, 31, v9
  v_and_b32 v101, v10, v9
  v_xor_b32 v117, v10, v101
  v_subrev_u32 v9, 10, v8
  v_ashrrev_i32 v9, 31, v9
  v_and_b32 v102, v10, v9
  v_xor_b32 v118, v10, v102
  v_subrev_u32 v9, 11, v8
  v_ashrrev_i32 v9, 31, v9
  v_and_b32 v103, v10, v9
  v_xor_b32 v119, v10, v103
  v_subrev_u32 v9, 16, v8
  v_ashrrev_i32 v9, 31, v9
  v_and_b32 v104, v10, v9
  v_xor_b32 v120, v10, v104
  v_subrev_u32 v9, 17, v8
  v_ashrrev_i32 v9, 31, v9
  v_and_b32 v105, v10, v9
  v_xor_b32 v121, v10, v105
  v_subrev_u32 v9, 18, v8
  v_ashrrev_i32 v9, 31, v9
  v_and_b32 v106, v10, v9
  v_xor_b32 v122, v10, v106
  v_subrev_u32 v9, 19, v8
  v_ashrrev_i32 v9, 31, v9
  v_and_b32 v107, v10, v9
  v_xor_b32 v123, v10, v107
  v_subrev_u32 v9, 24, v8
  v_ashrrev_i32 v9, 31, v9
  v_and_b32 v108, v10, v9
  v_xor_b32 v124, v10, v108
  v_subrev_u32 v9, 25, v8
  v_ashrrev_i32 v9, 31, v9
  v_and_b32 v109, v10, v9
  v_xor_b32 v125, v10, v109
  v_subrev_u32 v9, 26, v8
  v_ashrrev_i32 v9, 31, v9
  v_and_b32 v110, v10, v9
  v_xor_b32 v126, v10, v110
  v_subrev_u32 v9, 27, v8
  v_ashrrev_i32 v9, 31, v9
  v_and_b32 v111, v10, v9
  v_xor_b32 v127, v10, v111
Lkp_43:
  s_waitcnt vmcnt(0)
  v_cmp_ne_u32 vcc, v13, v15
  s_bitcmp1_b32 s65, 0
  s_cbranch_scc1 Lko_44
  s_and_b32 s60, vcc_lo, 0xffff0000
  s_cbranch_scc1 Lko_44
  s_add_u32 s60, s64, 63488
  s_mov_b32 m0, s60
  s_add_u32 s61, s63, 0
  buffer_load_dwordx4 v2, s[24:27], s61 offen sc1 lds
  s_add_u32 s60, s64, 79872
  s_mov_b32 m0, s60
  s_add_u32 s61, s63, 2097152
  buffer_load_dwordx4 v2, s[24:27], s61 offen sc1 lds
  s_add_u32 s60, s64, 67584
  s_mov_b32 m0, s60
  s_add_u32 s61, s63, 131072
  buffer_load_dwordx4 v2, s[24:27], s61 offen sc1 lds
  s_add_u32 s60, s64, 83968
  s_mov_b32 m0, s60
  s_add_u32 s61, s63, 2228224
  buffer_load_dwordx4 v2, s[24:27], s61 offen sc1 lds
  s_or_b32 s65, s65, 1
Lko_44:
  s_bitcmp1_b32 s65, 1
  s_cbranch_scc1 Lkc_45
  s_and_b32 s60, vcc_lo, 0x0000ffff
  s_or_b32 s60, s60, vcc_hi
  s_cbranch_scc1 Lkc_45
  buffer_load_dwordx4 v[16:19], v2, s[24:27], s55 offen sc1
  s_add_u32 s60, s64, 71680
  s_mov_b32 m0, s60
  s_add_u32 s61, s62, 32768
  buffer_load_dwordx4 v2, s[24:27], s61 offen sc1 lds
  s_add_u32 s60, s64, 88064
  s_mov_b32 m0, s60
  s_add_u32 s61, s62, 65536
  buffer_load_dwordx4 v2, s[24:27], s61 offen sc1 lds
  s_add_u32 s60, s64, 75776
  s_mov_b32 m0, s60
  s_add_u32 s61, s62, 425984
  buffer_load_dwordx4 v2, s[24:27], s61 offen sc1 lds
  s_add_u32 s60, s64, 92160
  s_mov_b32 m0, s60
  s_add_u32 s61, s62, 458752
  buffer_load_dwordx4 v2, s[24:27], s61 offen sc1 lds
  s_or_b32 s65, s65, 2
Lkc_45:
  s_cmp_eq_u32 s65, 3
  s_cbranch_scc1 Lkd_46
  s_sub_u32 s79, s79, 1
  s_cbranch_scc1 Lkd_46
  buffer_load_dword v15, v12, s[24:27], s78 offen sc1
  s_branch Lkp_43
Lkd_46:
  s_branch Laj_42
Lam_41:
  v_lshrrev_b32 v14, 3, v1
  v_mul_u32_u24 v14, 1024, v14
  v_bfe_u32 v15, v1, 4, 1
  v_lshlrev_b32 v15, 2, v15
  v_xor_b32 v15, v15, v1
  v_and_b32 v15, 7, v15
  v_lshl_add_u32 v137, v15, 4, v14
  s_and_b32 s56, s41, 7
  s_lshl_b32 s56, s56, 7
  s_lshl_b32 s83, s42, 13
  s_add_u32 s56, s56, s83
  s_add_u32 s56, s56, 196608
  s_lshl_b32 s57, s42, 10
  s_add_u32 s57, s57, 122880
  s_lshr_b32 s58, s41, 3
  s_mul_i32 s58, s58, 10
  s_lshr_b32 s58, s58, 2
  s_mov_b32 s73, s58
  s_mul_i32 s74, s73, 32768
  s_mul_i32 s75, s73, 4096
  s_add_u32 s74, s74, s56
  s_add_u32 s75, s75, s57
  s_cmp_eq_u32 s75, 162816
  s_cselect_b32 s75, 97280, s75
  s_mov_b32 m0, s75
  s_add_u32 s73, s73, 1
  buffer_load_dwordx4 v137, s[12:15], s74 offen lds
  s_cmp_eq_u32 s73, 10
  s_cselect_b32 s73, 0, s73
  s_mul_i32 s74, s73, 32768
  s_mul_i32 s75, s73, 4096
  s_add_u32 s74, s74, s56
  s_add_u32 s75, s75, s57
  s_cmp_eq_u32 s75, 162816
  s_cselect_b32 s75, 97280, s75
  s_mov_b32 m0, s75
  s_add_u32 s73, s73, 1
  buffer_load_dwordx4 v137, s[12:15], s74 offen lds
  s_cmp_eq_u32 s73, 10
  s_cselect_b32 s73, 0, s73
  s_mul_i32 s74, s73, 32768
  s_mul_i32 s75, s73, 4096
  s_add_u32 s74, s74, s56
  s_add_u32 s75, s75, s57
  s_cmp_eq_u32 s75, 162816
  s_cselect_b32 s75, 97280, s75
  s_mov_b32 m0, s75
  s_add_u32 s73, s73, 1
  buffer_load_dwordx4 v137, s[12:15], s74 offen lds
  s_cmp_eq_u32 s73, 10
  s_cselect_b32 s73, 0, s73
  s_mul_i32 s74, s73, 32768
  s_mul_i32 s75, s73, 4096
  s_add_u32 s74, s74, s56
  s_add_u32 s75, s75, s57
  s_cmp_eq_u32 s75, 162816
  s_cselect_b32 s75, 97280, s75
  s_mov_b32 m0, s75
  s_add_u32 s73, s73, 1
  buffer_load_dwordx4 v137, s[12:15], s74 offen lds
  s_cmp_eq_u32 s73, 10
  s_cselect_b32 s73, 0, s73
  s_mul_i32 s74, s73, 32768
  s_mul_i32 s75, s73, 4096
  s_add_u32 s74, s74, s56
  s_add_u32 s75, s75, s57
  s_cmp_eq_u32 s75, 162816
  s_cselect_b32 s75, 97280, s75
  s_mov_b32 m0, s75
  s_add_u32 s73, s73, 1
  buffer_load_dwordx4 v137, s[12:15], s74 offen lds
  s_cmp_eq_u32 s73, 10
  s_cselect_b32 s73, 0, s73
  s_mul_i32 s74, s73, 32768
  s_mul_i32 s75, s73, 4096
  s_add_u32 s74, s74, s56
  s_add_u32 s75, s75, s57
  s_cmp_eq_u32 s75, 162816
  s_cselect_b32 s75, 97280, s75
  s_mov_b32 m0, s75
  s_add_u32 s73, s73, 1
  buffer_load_dwordx4 v137, s[12:15], s74 offen lds
  s_cmp_eq_u32 s73, 10
  s_cselect_b32 s73, 0, s73
  s_mul_i32 s74, s73, 32768
  s_mul_i32 s75, s73, 4096
  s_add_u32 s74, s74, s56
  s_add_u32 s75, s75, s57
  s_cmp_eq_u32 s75, 162816
  s_cselect_b32 s75, 97280, s75
  s_mov_b32 m0, s75
  s_add_u32 s73, s73, 1
  buffer_load_dwordx4 v137, s[12:15], s74 offen lds
  s_cmp_eq_u32 s73, 10
  s_cselect_b32 s73, 0, s73
  s_mul_i32 s74, s73, 32768
  s_mul_i32 s75, s73, 4096
  s_add_u32 s74, s74, s56
  s_add_u32 s75, s75, s57
  s_cmp_eq_u32 s75, 162816
  s_cselect_b32 s75, 97280, s75
  s_mov_b32 m0, s75
  s_add_u32 s73, s73, 1
  buffer_load_dwordx4 v137, s[12:15], s74 offen lds
  s_cmp_eq_u32 s73, 10
  s_cselect_b32 s73, 0, s73
  s_mul_i32 s74, s73, 32768
  s_mul_i32 s75, s73, 4096
  s_add_u32 s74, s74, s56
  s_add_u32 s75, s75, s57
  s_cmp_eq_u32 s75, 162816
  s_cselect_b32 s75, 97280, s75
  s_mov_b32 m0, s75
  s_add_u32 s73, s73, 1
  buffer_load_dwordx4 v137, s[12:15], s74 offen lds
  s_cmp_eq_u32 s73, 10
  s_cselect_b32 s73, 0, s73
  s_mul_i32 s74, s73, 32768
  s_mul_i32 s75, s73, 4096
  s_add_u32 s74, s74, s56
  s_add_u32 s75, s75, s57
  s_cmp_eq_u32 s75, 162816
  s_cselect_b32 s75, 97280, s75
  s_mov_b32 m0, s75
  s_add_u32 s73, s73, 1
  buffer_load_dwordx4 v137, s[12:15], s74 offen lds
  s_cmp_eq_u32 s2, s2
  s_cbranch_scc1 Lwo0_48
  s_sub_u32 s56, s56, 196608
  s_sub_u32 s57, s57, 24576
  s_lshr_b32 s58, s41, 3
  s_mul_i32 s58, s58, 6
  s_lshr_b32 s58, s58, 2
  s_mov_b32 s73, s58
  s_mul_i32 s74, s73, 32768
  s_mul_i32 s75, s73, 4096
  s_add_u32 s74, s74, s56
  s_add_u32 s75, s75, s57
  s_mov_b32 m0, s75
  s_add_u32 s73, s73, 1
  buffer_load_dwordx4 v137, s[12:15], s74 offen lds
  s_cmp_eq_u32 s73, 6
  s_cselect_b32 s73, 0, s73
  s_mul_i32 s74, s73, 32768
  s_mul_i32 s75, s73, 4096
  s_add_u32 s74, s74, s56
  s_add_u32 s75, s75, s57
  s_mov_b32 m0, s75
  s_add_u32 s73, s73, 1
  buffer_load_dwordx4 v137, s[12:15], s74 offen lds
  s_cmp_eq_u32 s73, 6
  s_cselect_b32 s73, 0, s73
  s_mul_i32 s74, s73, 32768
  s_mul_i32 s75, s73, 4096
  s_add_u32 s74, s74, s56
  s_add_u32 s75, s75, s57
  s_mov_b32 m0, s75
  s_add_u32 s73, s73, 1
  buffer_load_dwordx4 v137, s[12:15], s74 offen lds
  s_cmp_eq_u32 s73, 6
  s_cselect_b32 s73, 0, s73
  s_mul_i32 s74, s73, 32768
  s_mul_i32 s75, s73, 4096
  s_add_u32 s74, s74, s56
  s_add_u32 s75, s75, s57
  s_mov_b32 m0, s75
  s_add_u32 s73, s73, 1
  buffer_load_dwordx4 v137, s[12:15], s74 offen lds
  s_cmp_eq_u32 s73, 6
  s_cselect_b32 s73, 0, s73
  s_mul_i32 s74, s73, 32768
  s_mul_i32 s75, s73, 4096
  s_add_u32 s74, s74, s56
  s_add_u32 s75, s75, s57
  s_mov_b32 m0, s75
  s_add_u32 s73, s73, 1
  buffer_load_dwordx4 v137, s[12:15], s74 offen lds
  s_cmp_eq_u32 s73, 6
  s_cselect_b32 s73, 0, s73
  s_mul_i32 s74, s73, 32768
  s_mul_i32 s75, s73, 4096
  s_add_u32 s74, s74, s56
  s_add_u32 s75, s75, s57
  s_mov_b32 m0, s75
  s_add_u32 s73, s73, 1
  buffer_load_dwordx4 v137, s[12:15], s74 offen lds
Lwo0_48:
  v_mov_b32 v12, 0
  s_mov_b32 s79, 262144
  buffer_load_dword v15, v12, s[24:27], s53 offen sc1
  v_and_b32 v8, 31, v1
  v_lshrrev_b32 v9, 2, v5
  v_sub_u32 v8, v8, v9
  v_mov_b32 v10, 0xf149f2ca
  v_subrev_u32 v9, 0, v8
  v_ashrrev_i32 v9, 31, v9
  v_and_b32 v96, v10, v9
  v_xor_b32 v112, v10, v96
  v_subrev_u32 v9, 1, v8
  v_ashrrev_i32 v9, 31, v9
  v_and_b32 v97, v10, v9
  v_xor_b32 v113, v10, v97
  v_subrev_u32 v9, 2, v8
  v_ashrrev_i32 v9, 31, v9
  v_and_b32 v98, v10, v9
  v_xor_b32 v114, v10, v98
  v_subrev_u32 v9, 3, v8
  v_ashrrev_i32 v9, 31, v9
  v_and_b32 v99, v10, v9
  v_xor_b32 v115, v10, v99
  v_subrev_u32 v9, 8, v8
  v_ashrrev_i32 v9, 31, v9
  v_and_b32 v100, v10, v9
  v_xor_b32 v116, v10, v100
  v_subrev_u32 v9, 9, v8
  v_ashrrev_i32 v9, 31, v9
  v_and_b32 v101, v10, v9
  v_xor_b32 v117, v10, v101
  v_subrev_u32 v9, 10, v8
  v_ashrrev_i32 v9, 31, v9
  v_and_b32 v102, v10, v9
  v_xor_b32 v118, v10, v102
  v_subrev_u32 v9, 11, v8
  v_ashrrev_i32 v9, 31, v9
  v_and_b32 v103, v10, v9
  v_xor_b32 v119, v10, v103
  v_subrev_u32 v9, 16, v8
  v_ashrrev_i32 v9, 31, v9
  v_and_b32 v104, v10, v9
  v_xor_b32 v120, v10, v104
  v_subrev_u32 v9, 17, v8
  v_ashrrev_i32 v9, 31, v9
  v_and_b32 v105, v10, v9
  v_xor_b32 v121, v10, v105
  v_subrev_u32 v9, 18, v8
  v_ashrrev_i32 v9, 31, v9
  v_and_b32 v106, v10, v9
  v_xor_b32 v122, v10, v106
  v_subrev_u32 v9, 19, v8
  v_ashrrev_i32 v9, 31, v9
  v_and_b32 v107, v10, v9
  v_xor_b32 v123, v10, v107
  v_subrev_u32 v9, 24, v8
  v_ashrrev_i32 v9, 31, v9
  v_and_b32 v108, v10, v9
  v_xor_b32 v124, v10, v108
  v_subrev_u32 v9, 25, v8
  v_ashrrev_i32 v9, 31, v9
  v_and_b32 v109, v10, v9
  v_xor_b32 v125, v10, v109
  v_subrev_u32 v9, 26, v8
  v_ashrrev_i32 v9, 31, v9
  v_and_b32 v110, v10, v9
  v_xor_b32 v126, v10, v110
  v_subrev_u32 v9, 27, v8
  v_ashrrev_i32 v9, 31, v9
  v_and_b32 v111, v10, v9
  v_xor_b32 v127, v10, v111
  s_waitcnt vmcnt(0)
  v_cmp_ne_u32 vcc, s43, v15
  s_cbranch_vccz Lpolld_50
Lpoll_49:
  buffer_load_dword v15, v12, s[24:27], s53 offen sc1
  s_sub_u32 s79, s79, 1
  s_cbranch_scc1 Lpolld_50
  s_waitcnt vmcnt(0)
  v_cmp_ne_u32 vcc, s43, v15
  s_cbranch_vccnz Lpoll_49
Lpolld_50:
  s_waitcnt vmcnt(0)
  buffer_load_dwordx4 v[16:19], v2, s[24:27], s55 offen sc1
Laj_42:
  s_cmp_ge_u32 s42, 4
  s_cbranch_scc1 Lres0_51
  s_cmp_lg_u32 s47, 0
  s_cbranch_scc1 Lres0_51
  s_lshr_b32 s60, s41, 3
  s_and_b32 s61, s42, 1
  s_lshl_b32 s60, s60, 1
  s_add_u32 s60, s60, s61
  s_lshl_b32 s83, s40, 3
  s_add_u32 s60, s60, s83
  s_and_b32 s61, s41, 7
  s_lshr_b32 s62, s42, 1
  s_lshl_b32 s61, s61, 1
  s_add_u32 s61, s61, s62
  s_lshl_b32 s60, s60, 15
  s_lshl_b32 s83, s61, 11
  s_add_u32 s60, s60, s83
  buffer_load_dwordx4 v[72:75], v2, s[24:27], s60 offen sc1
  buffer_load_dwordx4 v[76:79], v2, s[24:27], s60 offen offset:1024 sc1
Lres0_51:
  s_cmp_ge_u32 s42, 4
  s_cbranch_scc1 Lpfh_52
  v_lshrrev_b32 v14, 2, v1
  v_mul_u32_u24 v14, 2752, v14
  v_and_b32 v15, 3, v1
  v_lshl_add_u32 v136, v15, 4, v14
  s_lshr_b32 s70, s41, 1
  s_mul_i32 s71, s70, 3
  s_lshl_b32 s72, s70, 1
  s_add_u32 s72, s72, 11
  s_cmp_lt_u32 s70, 11
  s_cselect_b32 s66, s71, s72
  s_add_u32 s66, s66, 2
  s_min_u32 s66, s66, 42
  s_mov_b32 s67, 44032
  s_lshl_b32 s68, s42, 3
  s_mul_i32 s69, s68, s67
  s_lshl_b32 s66, s66, 6
  s_add_u32 s66, s66, s69
  s_lshl_b32 s68, s68, 10
  s_branch Lpfd_53
Lpfh_52:
  v_lshrrev_b32 v14, 3, v1
  v_mul_u32_u24 v14, 2752, v14
  v_bfe_u32 v15, v1, 4, 1
  v_lshlrev_b32 v15, 2, v15
  v_xor_b32 v15, v15, v1
  v_and_b32 v15, 7, v15
  v_lshl_add_u32 v136, v15, 4, v14
  s_lshr_b32 s70, s41, 1
  s_mul_i32 s71, s70, 3
  s_lshl_b32 s72, s70, 1
  s_add_u32 s72, s72, 11
  s_cmp_lt_u32 s70, 11
  s_cselect_b32 s66, s71, s72
  s_min_u32 s66, s66, 42
  s_mov_b32 s67, 22016
  s_sub_u32 s68, s42, 4
  s_lshl_b32 s68, s68, 3
  s_min_u32 s68, s68, 22
  s_mul_i32 s69, s68, s67
  s_lshl_b32 s66, s66, 6
  s_add_u32 s66, s66, s69
  s_lshl_b32 s68, s68, 10
  s_add_u32 s68, s68, 32768
Lpfd_53:
  s_and_b32 s76, s41, 1
  s_lshl_b32 s76, s76, 2
  s_mul_i32 s69, s76, s67
  s_add_u32 s66, s66, s69
  s_lshl_b32 s69, s69, 1
  s_lshl_b32 s76, s76, 10
  s_add_u32 s68, s68, s76
  s_lshl_b32 s76, s76, 1
  s_lshl_b32 s62, s42, 10
  s_mov_b32 s63, s62
  s_add_u32 s63, s63, 63488
  v_add_u32 v8, s63, v2
  v_lshrrev_b32 v9, 2, v5
  v_bfe_u32 v10, v1, 2, 2
  v_add_u32 v9, v9, v10
  v_lshlrev_b32 v9, 5, v9
  v_and_b32 v10, 3, v1
  v_lshl_add_u32 v9, v10, 3, v9
  s_add_u32 s63, s62, 79872
  v_add_u32 v9, s63, v9
  v_lshlrev_b32 v10, 3, v10
  v_lshlrev_b32 v11, 3, v5
  v_sub_u32 v10, v10, v11
  v_add_u32 v10, 96384, v10
  v_and_b32 v11, 16, v1
  v_cmp_eq_u32 vcc, 0, v11
  v_mov_b32 v11, 1024
  v_mov_b32 v12, 0
  v_cndmask_b32 v9, v10, v9, vcc
  v_cndmask_b32 v10, v12, v11, vcc
  s_mov_b32 s55, s54
  s_lshl_b32 s56, s82, 5
  s_add_u32 s56, s56, s41
  s_lshl_b32 s56, s56, 2
  s_add_u32 s56, s56, s46
  s_add_u32 s56, s56, 13901824
  s_waitcnt vmcnt(0) lgkmcnt(0)
  s_barrier
  s_cmp_lg_u32 s42, 4
  s_cbranch_scc1 Llt_54
  s_cmp_lg_u32 s47, 0
  s_cbranch_scc1 Llt_54
  v_lshlrev_b32 v244, 7, v1
  v_min_u32 v244, 5376, v244
  s_mul_i32 s83, s2, 5504
  buffer_load_dword v243, v244, s[20:23], s83 offen
Llt_54:
  s_cmp_lt_u32 s42, 4
  s_cbranch_scc1 Lprio_55
  s_setprio 1
Lprio_55:
  s_sub_u32 s70, 8, s42
  s_cmp_eq_u32 s40, 0
  s_cselect_b32 s70, s70, 99
  s_cselect_b32 s71, 16384, 0
  v_bfe_u32 v11, v1, 4, 1
  v_mul_u32_u24 v12, s71, v11
  v_sub_u32 v9, v9, v12
Lfast_58:
  ds_read_b128 v[20:23], v8 offset:0
  ds_read_b128 v[24:27], v8 offset:1024
  ds_read_b64_tr_b16 v[28:29], v9 offset:0
  ds_read_b64_tr_b16 v[30:31], v9 offset:256
  ds_read_b64_tr_b16 v[140:141], v9 offset:512
  ds_read_b64_tr_b16 v[142:143], v9 offset:768
  v_add_u32 v9, v9, v10
  s_cmp_eq_u32 s70, 1
  s_cselect_b32 s72, s71, 0
  v_mad_u32_u24 v9, v11, s72, v9
  s_waitcnt lgkmcnt(5)
  v_mfma_f32_32x32x16_bf16 v[32:47], v[20:23], v[16:19], v[112:127]
  s_waitcnt lgkmcnt(4)
  v_mfma_f32_32x32x16_bf16 v[48:63], v[24:27], v[16:19], 0
  ds_read_b128 v[20:23], v8 offset:2048
  s_nop 8
  v_exp_f32 v32, v32
  v_exp_f32 v33, v33
  v_exp_f32 v34, v34
  v_exp_f32 v35, v35
  v_exp_f32 v36, v36
  v_exp_f32 v37, v37
  v_exp_f32 v38, v38
  v_exp_f32 v39, v39
  ds_read_b64_tr_b16 v[128:129], v9 offset:0
  ds_read_b64_tr_b16 v[130:131], v9 offset:256
  ds_read_b64_tr_b16 v[132:133], v9 offset:512
  ds_read_b64_tr_b16 v[134:135], v9 offset:768
  v_add_u32 v9, v9, v10
  s_cmp_eq_u32 s70, 2
  s_cselect_b32 s72, s71, 0
  v_mad_u32_u24 v9, v11, s72, v9
  v_cvt_pk_bf16_f32 v64, v32, v33
  v_cvt_pk_bf16_f32 v65, v34, v35
  v_cvt_pk_bf16_f32 v66, v36, v37
  v_cvt_pk_bf16_f32 v67, v38, v39
  v_exp_f32 v40, v40
  v_exp_f32 v41, v41
  v_exp_f32 v42, v42
  v_exp_f32 v43, v43
  s_waitcnt lgkmcnt(5)
  v_mfma_f32_32x32x16_bf16 v[80:95], v[28:31], v[64:67], 0
  v_exp_f32 v44, v44
  v_exp_f32 v45, v45
  v_exp_f32 v46, v46
  v_exp_f32 v47, v47
  s_mov_b32 m0, s68
  s_add_u32 s68, s68, 1024
  buffer_load_dwordx4 v136, s[16:19], s66 offen lds
  s_add_u32 s66, s66, s67
  v_cvt_pk_bf16_f32 v68, v40, v41
  v_cvt_pk_bf16_f32 v69, v42, v43
  v_cvt_pk_bf16_f32 v70, v44, v45
  v_cvt_pk_bf16_f32 v71, v46, v47
  s_nop 1
  v_mfma_f32_32x32x16_bf16 v[80:95], v[140:143], v[68:71], v[80:95]
  s_waitcnt lgkmcnt(4)
  v_mfma_f32_32x32x16_bf16 v[32:47], v[20:23], v[16:19], 0
  ds_read_b128 v[24:27], v8 offset:3072
  v_exp_f32 v48, v48
  v_exp_f32 v49, v49
  v_exp_f32 v50, v50
  v_exp_f32 v51, v51
  v_exp_f32 v52, v52
  v_exp_f32 v53, v53
  v_exp_f32 v54, v54
  v_exp_f32 v55, v55
  ds_read_b64_tr_b16 v[28:29], v9 offset:0
  ds_read_b64_tr_b16 v[30:31], v9 offset:256
  ds_read_b64_tr_b16 v[140:141], v9 offset:512
  ds_read_b64_tr_b16 v[142:143], v9 offset:768
  v_add_u32 v9, v9, v10
  s_cmp_eq_u32 s70, 3
  s_cselect_b32 s72, s71, 0
  v_mad_u32_u24 v9, v11, s72, v9
  v_cvt_pk_bf16_f32 v64, v48, v49
  v_cvt_pk_bf16_f32 v65, v50, v51
  v_cvt_pk_bf16_f32 v66, v52, v53
  v_cvt_pk_bf16_f32 v67, v54, v55
  v_exp_f32 v56, v56
  v_exp_f32 v57, v57
  v_exp_f32 v58, v58
  v_exp_f32 v59, v59
  s_waitcnt lgkmcnt(5)
  v_mfma_f32_32x32x16_bf16 v[80:95], v[128:131], v[64:67], v[80:95]
  v_exp_f32 v60, v60
  v_exp_f32 v61, v61
  v_exp_f32 v62, v62
  v_exp_f32 v63, v63
  s_mov_b32 m0, s68
  s_add_u32 s68, s68, 1024
  buffer_load_dwordx4 v136, s[16:19], s66 offen lds
  s_add_u32 s66, s66, s67
  v_cvt_pk_bf16_f32 v68, v56, v57
  v_cvt_pk_bf16_f32 v69, v58, v59
  v_cvt_pk_bf16_f32 v70, v60, v61
  v_cvt_pk_bf16_f32 v71, v62, v63
  s_nop 1
  v_mfma_f32_32x32x16_bf16 v[80:95], v[132:135], v[68:71], v[80:95]
  s_waitcnt lgkmcnt(4)
  v_mfma_f32_32x32x16_bf16 v[48:63], v[24:27], v[16:19], 0
  ds_read_b128 v[20:23], v8 offset:4096
  v_exp_f32 v32, v32
  v_exp_f32 v33, v33
  v_exp_f32 v34, v34
  v_exp_f32 v35, v35
  v_exp_f32 v36, v36
  v_exp_f32 v37, v37
  v_exp_f32 v38, v38
  v_exp_f32 v39, v39
  ds_read_b64_tr_b16 v[128:129], v9 offset:0
  ds_read_b64_tr_b16 v[130:131], v9 offset:256
  ds_read_b64_tr_b16 v[132:133], v9 offset:512
  ds_read_b64_tr_b16 v[134:135], v9 offset:768
  v_add_u32 v9, v9, v10
  s_cmp_eq_u32 s70, 4
  s_cselect_b32 s72, s71, 0
  v_mad_u32_u24 v9, v11, s72, v9
  v_cvt_pk_bf16_f32 v64, v32, v33
  v_cvt_pk_bf16_f32 v65, v34, v35
  v_cvt_pk_bf16_f32 v66, v36, v37
  v_cvt_pk_bf16_f32 v67, v38, v39
  v_exp_f32 v40, v40
  v_exp_f32 v41, v41
  v_exp_f32 v42, v42
  v_exp_f32 v43, v43
  s_waitcnt lgkmcnt(5)
  v_mfma_f32_32x32x16_bf16 v[80:95], v[28:31], v[64:67], v[80:95]
  v_exp_f32 v44, v44
  v_exp_f32 v45, v45
  v_exp_f32 v46, v46
  v_exp_f32 v47, v47
  s_mov_b32 m0, s68
  s_add_u32 s68, s68, 1024
  buffer_load_dwordx4 v136, s[16:19], s66 offen lds
  s_add_u32 s66, s66, s67
  v_cvt_pk_bf16_f32 v68, v40, v41
  v_cvt_pk_bf16_f32 v69, v42, v43
  v_cvt_pk_bf16_f32 v70, v44, v45
  v_cvt_pk_bf16_f32 v71, v46, v47
  s_nop 1
  v_mfma_f32_32x32x16_bf16 v[80:95], v[140:143], v[68:71], v[80:95]
  s_waitcnt lgkmcnt(4)
  v_mfma_f32_32x32x16_bf16 v[32:47], v[20:23], v[16:19], 0
  ds_read_b128 v[24:27], v8 offset:5120
  v_exp_f32 v48, v48
  v_exp_f32 v49, v49
  v_exp_f32 v50, v50
  v_exp_f32 v51, v51
  v_exp_f32 v52, v52
  v_exp_f32 v53, v53
  v_exp_f32 v54, v54
  v_exp_f32 v55, v55
  ds_read_b64_tr_b16 v[28:29], v9 offset:0
  ds_read_b64_tr_b16 v[30:31], v9 offset:256
  ds_read_b64_tr_b16 v[140:141], v9 offset:512
  ds_read_b64_tr_b16 v[142:143], v9 offset:768
  v_add_u32 v9, v9, v10
  s_cmp_eq_u32 s70, 5
  s_cselect_b32 s72, s71, 0
  v_mad_u32_u24 v9, v11, s72, v9
  v_cvt_pk_bf16_f32 v64, v48, v49
  v_cvt_pk_bf16_f32 v65, v50, v51
  v_cvt_pk_bf16_f32 v66, v52, v53
  v_cvt_pk_bf16_f32 v67, v54, v55
  v_exp_f32 v56, v56
  v_exp_f32 v57, v57
  v_exp_f32 v58, v58
  v_exp_f32 v59, v59
  s_waitcnt lgkmcnt(5)
  v_mfma_f32_32x32x16_bf16 v[80:95], v[128:131], v[64:67], v[80:95]
  v_exp_f32 v60, v60
  v_exp_f32 v61, v61
  v_exp_f32 v62, v62
  v_exp_f32 v63, v63
  s_mov_b32 m0, s68
  s_add_u32 s68, s68, 1024
  buffer_load_dwordx4 v136, s[16:19], s66 offen lds
  s_add_u32 s66, s66, s67
  v_cvt_pk_bf16_f32 v68, v56, v57
  v_cvt_pk_bf16_f32 v69, v58, v59
  v_cvt_pk_bf16_f32 v70, v60, v61
  v_cvt_pk_bf16_f32 v71, v62, v63
  s_nop 1
  v_mfma_f32_32x32x16_bf16 v[80:95], v[132:135], v[68:71], v[80:95]
  s_waitcnt lgkmcnt(4)
  v_mfma_f32_32x32x16_bf16 v[48:63], v[24:27], v[16:19], 0
  ds_read_b128 v[20:23], v8 offset:6144
  v_exp_f32 v32, v32
  v_exp_f32 v33, v33
  v_exp_f32 v34, v34
  v_exp_f32 v35, v35
  v_exp_f32 v36, v36
  v_exp_f32 v37, v37
  v_exp_f32 v38, v38
  v_exp_f32 v39, v39
  ds_read_b64_tr_b16 v[128:129], v9 offset:0
  ds_read_b64_tr_b16 v[130:131], v9 offset:256
  ds_read_b64_tr_b16 v[132:133], v9 offset:512
  ds_read_b64_tr_b16 v[134:135], v9 offset:768
  v_add_u32 v9, v9, v10
  s_cmp_eq_u32 s70, 6
  s_cselect_b32 s72, s71, 0
  v_mad_u32_u24 v9, v11, s72, v9
  v_cvt_pk_bf16_f32 v64, v32, v33
  v_cvt_pk_bf16_f32 v65, v34, v35
  v_cvt_pk_bf16_f32 v66, v36, v37
  v_cvt_pk_bf16_f32 v67, v38, v39
  v_exp_f32 v40, v40
  v_exp_f32 v41, v41
  v_exp_f32 v42, v42
  v_exp_f32 v43, v43
  s_waitcnt lgkmcnt(5)
  v_mfma_f32_32x32x16_bf16 v[80:95], v[28:31], v[64:67], v[80:95]
  v_exp_f32 v44, v44
  v_exp_f32 v45, v45
  v_exp_f32 v46, v46
  v_exp_f32 v47, v47
  s_sub_u32 s66, s66, s69
  s_sub_u32 s68, s68, s76
  s_mov_b32 m0, s68
  s_add_u32 s68, s68, 1024
  buffer_load_dwordx4 v136, s[16:19], s66 offen lds
  s_add_u32 s66, s66, s67
  v_cvt_pk_bf16_f32 v68, v40, v41
  v_cvt_pk_bf16_f32 v69, v42, v43
  v_cvt_pk_bf16_f32 v70, v44, v45
  v_cvt_pk_bf16_f32 v71, v46, v47
  s_nop 1
  v_mfma_f32_32x32x16_bf16 v[80:95], v[140:143], v[68:71], v[80:95]
  s_waitcnt lgkmcnt(4)
  v_mfma_f32_32x32x16_bf16 v[32:47], v[20:23], v[16:19], 0
  ds_read_b128 v[24:27], v8 offset:7168
  v_exp_f32 v48, v48
  v_exp_f32 v49, v49
  v_exp_f32 v50, v50
  v_exp_f32 v51, v51
  v_exp_f32 v52, v52
  v_exp_f32 v53, v53
  v_exp_f32 v54, v54
  v_exp_f32 v55, v55
  ds_read_b64_tr_b16 v[28:29], v9 offset:0
  ds_read_b64_tr_b16 v[30:31], v9 offset:256
  ds_read_b64_tr_b16 v[140:141], v9 offset:512
  ds_read_b64_tr_b16 v[142:143], v9 offset:768
  v_add_u32 v9, v9, v10
  s_cmp_eq_u32 s70, 7
  s_cselect_b32 s72, s71, 0
  v_mad_u32_u24 v9, v11, s72, v9
  v_cvt_pk_bf16_f32 v64, v48, v49
  v_cvt_pk_bf16_f32 v65, v50, v51
  v_cvt_pk_bf16_f32 v66, v52, v53
  v_cvt_pk_bf16_f32 v67, v54, v55
  v_exp_f32 v56, v56
  v_exp_f32 v57, v57
  v_exp_f32 v58, v58
  v_exp_f32 v59, v59
  s_waitcnt lgkmcnt(5)
  v_mfma_f32_32x32x16_bf16 v[80:95], v[128:131], v[64:67], v[80:95]
  v_exp_f32 v60, v60
  v_exp_f32 v61, v61
  v_exp_f32 v62, v62
  v_exp_f32 v63, v63
  s_mov_b32 m0, s68
  s_add_u32 s68, s68, 1024
  buffer_load_dwordx4 v136, s[16:19], s66 offen lds
  s_add_u32 s66, s66, s67
  v_cvt_pk_bf16_f32 v68, v56, v57
  v_cvt_pk_bf16_f32 v69, v58, v59
  v_cvt_pk_bf16_f32 v70, v60, v61
  v_cvt_pk_bf16_f32 v71, v62, v63
  s_nop 1
  v_mfma_f32_32x32x16_bf16 v[80:95], v[132:135], v[68:71], v[80:95]
  s_waitcnt lgkmcnt(4)
  v_mfma_f32_32x32x16_bf16 v[48:63], v[24:27], v[16:19], 0
  ds_read_b128 v[20:23], v8 offset:8192
  v_exp_f32 v32, v32
  v_exp_f32 v33, v33
  v_exp_f32 v34, v34
  v_exp_f32 v35, v35
  v_exp_f32 v36, v36
  v_exp_f32 v37, v37
  v_exp_f32 v38, v38
  v_exp_f32 v39, v39
  ds_read_b64_tr_b16 v[128:129], v9 offset:0
  ds_read_b64_tr_b16 v[130:131], v9 offset:256
  ds_read_b64_tr_b16 v[132:133], v9 offset:512
  ds_read_b64_tr_b16 v[134:135], v9 offset:768
  v_add_u32 v9, v9, v10
  s_cmp_eq_u32 s70, 8
  s_cselect_b32 s72, s71, 0
  v_mad_u32_u24 v9, v11, s72, v9
  v_cvt_pk_bf16_f32 v64, v32, v33
  v_cvt_pk_bf16_f32 v65, v34, v35
  v_cvt_pk_bf16_f32 v66, v36, v37
  v_cvt_pk_bf16_f32 v67, v38, v39
  v_exp_f32 v40, v40
  v_exp_f32 v41, v41
  v_exp_f32 v42, v42
  v_exp_f32 v43, v43
  s_waitcnt lgkmcnt(5)
  v_mfma_f32_32x32x16_bf16 v[80:95], v[28:31], v[64:67], v[80:95]
  v_exp_f32 v44, v44
  v_exp_f32 v45, v45
  v_exp_f32 v46, v46
  v_exp_f32 v47, v47
  s_mov_b32 m0, s68
  s_add_u32 s68, s68, 1024
  buffer_load_dwordx4 v136, s[16:19], s66 offen lds
  s_add_u32 s66, s66, s67
  v_cvt_pk_bf16_f32 v68, v40, v41
  v_cvt_pk_bf16_f32 v69, v42, v43
  v_cvt_pk_bf16_f32 v70, v44, v45
  v_cvt_pk_bf16_f32 v71, v46, v47
  s_nop 1
  v_mfma_f32_32x32x16_bf16 v[80:95], v[140:143], v[68:71], v[80:95]
  s_waitcnt lgkmcnt(4)
  v_mfma_f32_32x32x16_bf16 v[32:47], v[20:23], v[16:19], v[96:111]
  v_exp_f32 v48, v48
  v_exp_f32 v49, v49
  v_exp_f32 v50, v50
  v_exp_f32 v51, v51
  v_exp_f32 v52, v52
  v_exp_f32 v53, v53
  v_exp_f32 v54, v54
  v_exp_f32 v55, v55
  ds_read_b64_tr_b16 v[28:29], v9 offset:0
  ds_read_b64_tr_b16 v[30:31], v9 offset:256
  ds_read_b64_tr_b16 v[140:141], v9 offset:512
  ds_read_b64_tr_b16 v[142:143], v9 offset:768
  v_cvt_pk_bf16_f32 v64, v48, v49
  v_cvt_pk_bf16_f32 v65, v50, v51
  v_cvt_pk_bf16_f32 v66, v52, v53
  v_cvt_pk_bf16_f32 v67, v54, v55
  v_exp_f32 v56, v56
  v_exp_f32 v57, v57
  v_exp_f32 v58, v58
  v_exp_f32 v59, v59
  s_waitcnt lgkmcnt(4)
  v_mfma_f32_32x32x16_bf16 v[80:95], v[128:131], v[64:67], v[80:95]
  v_exp_f32 v60, v60
  v_exp_f32 v61, v61
  v_exp_f32 v62, v62
  v_exp_f32 v63, v63
  s_mov_b32 m0, s68
  s_add_u32 s68, s68, 1024
  buffer_load_dwordx4 v136, s[16:19], s66 offen lds
  s_add_u32 s66, s66, s67
  v_cvt_pk_bf16_f32 v68, v56, v57
  v_cvt_pk_bf16_f32 v69, v58, v59
  v_cvt_pk_bf16_f32 v70, v60, v61
  v_cvt_pk_bf16_f32 v71, v62, v63
  s_nop 1
  v_mfma_f32_32x32x16_bf16 v[80:95], v[132:135], v[68:71], v[80:95]
  v_exp_f32 v32, v32
  v_exp_f32 v33, v33
  v_exp_f32 v34, v34
  v_exp_f32 v35, v35
  v_exp_f32 v36, v36
  v_exp_f32 v37, v37
  v_exp_f32 v38, v38
  v_exp_f32 v39, v39
  v_cvt_pk_bf16_f32 v64, v32, v33
  v_cvt_pk_bf16_f32 v65, v34, v35
  v_cvt_pk_bf16_f32 v66, v36, v37
  v_cvt_pk_bf16_f32 v67, v38, v39
  v_exp_f32 v40, v40
  v_exp_f32 v41, v41
  v_exp_f32 v42, v42
  v_exp_f32 v43, v43
  s_waitcnt lgkmcnt(0)
  v_mfma_f32_32x32x16_bf16 v[80:95], v[28:31], v[64:67], v[80:95]
  v_exp_f32 v44, v44
  v_exp_f32 v45, v45
  v_exp_f32 v46, v46
  v_exp_f32 v47, v47
  v_cvt_pk_bf16_f32 v68, v40, v41
  v_cvt_pk_bf16_f32 v69, v42, v43
  v_cvt_pk_bf16_f32 v70, v44, v45
  v_cvt_pk_bf16_f32 v71, v46, v47
  s_nop 1
  v_mfma_f32_32x32x16_bf16 v[80:95], v[140:143], v[68:71], v[80:95]
  v_mov_b32 v8, 0x2b800000
  v_mov_b32 v9, 0x53800000
  v_mov_b32 v10, 0
  s_nop 8
  v_fmac_f32 v10, 0, v80
  v_fmac_f32 v10, 0, v81
  v_fmac_f32 v10, 0, v82
  v_fmac_f32 v10, 0, v83
  v_fmac_f32 v10, 0, v84
  v_fmac_f32 v10, 0, v85
  v_fmac_f32 v10, 0, v86
  v_fmac_f32 v10, 0, v87
  v_cmp_nge_f32 vcc, v88, v8
  v_cmp_nle_f32 s[64:65], v88, v9
  s_nop 0
  s_or_b64 vcc, vcc, s[64:65]
  v_cmp_u_f32 s[64:65], v10, v10
  s_nop 0
  s_or_b64 vcc, vcc, s[64:65]
  s_cbranch_vccz Ladone_57
Lgen_56:
  s_cmp_eq_u32 s40, 0
  s_cselect_b32 s60, 8, s42
  s_cselect_b32 s61, s42, 7
  s_lshl_b32 s62, s60, 10
  s_add_u32 s63, s62, 63488
  v_add_u32 v8, s63, v2
  v_mov_b32 v24, v8
  v_lshrrev_b32 v9, 2, v5
  v_bfe_u32 v10, v1, 2, 2
  v_add_u32 v9, v9, v10
  v_lshlrev_b32 v9, 5, v9
  v_and_b32 v10, 3, v1
  v_lshl_add_u32 v9, v10, 3, v9
  s_add_u32 s63, s62, 79872
  v_add_u32 v9, s63, v9
  v_lshlrev_b32 v10, 3, v10
  v_lshlrev_b32 v11, 3, v5
  v_sub_u32 v10, v10, v11
  v_add_u32 v10, 96384, v10
  v_and_b32 v11, 16, v1
  v_cmp_eq_u32 vcc, 0, v11
  v_mov_b32 v11, 1024
  v_mov_b32 v12, 0
  v_cndmask_b32 v9, v10, v9, vcc
  v_cndmask_b32 v10, v12, v11, vcc
  v_mov_b32 v11, 0xf149f2ca
  s_mov_b32 s64, s61
  s_cmp_eq_u32 s40, 0
  s_cbranch_scc1 La_59
  ds_read_b128 v[20:23], v8
  v_add_u32 v8, 1024, v8
  s_waitcnt lgkmcnt(0)
  v_mfma_f32_32x32x16_bf16 v[32:47], v[20:23], v[16:19], v[112:127]
  s_nop 11
  v_max3_f32 v11, v32, v33, v11
  v_max3_f32 v11, v34, v35, v11
  v_max3_f32 v11, v36, v37, v11
  v_max3_f32 v11, v38, v39, v11
  v_max3_f32 v11, v40, v41, v11
  v_max3_f32 v11, v42, v43, v11
  v_max3_f32 v11, v44, v45, v11
  v_max3_f32 v11, v46, v47, v11
La_59:
  s_cmp_eq_u32 s64, 0
  s_cbranch_scc1 Ld_61
Lm_60:
  ds_read_b128 v[20:23], v8
  v_add_u32 v8, 1024, v8
  s_waitcnt lgkmcnt(0)
  v_mfma_f32_32x32x16_bf16 v[32:47], v[20:23], v[16:19], 0
  s_nop 11
  v_max3_f32 v11, v32, v33, v11
  v_max3_f32 v11, v34, v35, v11
  v_max3_f32 v11, v36, v37, v11
  v_max3_f32 v11, v38, v39, v11
  v_max3_f32 v11, v40, v41, v11
  v_max3_f32 v11, v42, v43, v11
  v_max3_f32 v11, v44, v45, v11
  v_max3_f32 v11, v46, v47, v11
  s_sub_u32 s64, s64, 1
  s_cmp_lg_u32 s64, 0
  s_cbranch_scc1 Lm_60
Ld_61:
  ds_read_b128 v[20:23], v8
  v_add_u32 v8, 1024, v8
  s_waitcnt lgkmcnt(0)
  v_mfma_f32_32x32x16_bf16 v[32:47], v[20:23], v[16:19], v[96:111]
  s_nop 11
  v_max3_f32 v11, v32, v33, v11
  v_max3_f32 v11, v34, v35, v11
  v_max3_f32 v11, v36, v37, v11
  v_max3_f32 v11, v38, v39, v11
  v_max3_f32 v11, v40, v41, v11
  v_max3_f32 v11, v42, v43, v11
  v_max3_f32 v11, v44, v45, v11
  v_max3_f32 v11, v46, v47, v11
  v_mov_b32 v12, v11
  s_nop 1
  v_permlane32_swap_b32 v11, v12
  v_max_f32 v11, v11, v12
  v_mov_b32 v8, v24
  v_mov_b32 v80, 0
  v_mov_b32 v81, 0
  v_mov_b32 v82, 0
  v_mov_b32 v83, 0
  v_mov_b32 v84, 0
  v_mov_b32 v85, 0
  v_mov_b32 v86, 0
  v_mov_b32 v87, 0
  v_mov_b32 v88, 0
  v_mov_b32 v89, 0
  v_mov_b32 v90, 0
  v_mov_b32 v91, 0
  v_mov_b32 v92, 0
  v_mov_b32 v93, 0
  v_mov_b32 v94, 0
  v_mov_b32 v95, 0
  s_mov_b32 s64, s61
  s_cmp_eq_u32 s40, 0
  s_cbranch_scc1 La_62
  ds_read_b64_tr_b16 v[28:29], v9 offset:0
  ds_read_b64_tr_b16 v[30:31], v9 offset:256
  ds_read_b64_tr_b16 v[140:141], v9 offset:512
  ds_read_b64_tr_b16 v[142:143], v9 offset:768
  ds_read_b128 v[20:23], v8
  v_add_u32 v8, 1024, v8
  s_waitcnt lgkmcnt(0)
  v_mfma_f32_32x32x16_bf16 v[32:47], v[20:23], v[16:19], v[112:127]
  v_add_u32 v9, v9, v10
  s_nop 10
  v_sub_f32 v32, v32, v11
  v_sub_f32 v33, v33, v11
  v_sub_f32 v34, v34, v11
  v_sub_f32 v35, v35, v11
  v_sub_f32 v36, v36, v11
  v_sub_f32 v37, v37, v11
  v_sub_f32 v38, v38, v11
  v_sub_f32 v39, v39, v11
  v_sub_f32 v40, v40, v11
  v_sub_f32 v41, v41, v11
  v_sub_f32 v42, v42, v11
  v_sub_f32 v43, v43, v11
  v_sub_f32 v44, v44, v11
  v_sub_f32 v45, v45, v11
  v_sub_f32 v46, v46, v11
  v_sub_f32 v47, v47, v11
  v_exp_f32 v32, v32
  v_exp_f32 v33, v33
  v_exp_f32 v34, v34
  v_exp_f32 v35, v35
  v_exp_f32 v36, v36
  v_exp_f32 v37, v37
  v_exp_f32 v38, v38
  v_exp_f32 v39, v39
  v_exp_f32 v40, v40
  v_exp_f32 v41, v41
  v_exp_f32 v42, v42
  v_exp_f32 v43, v43
  v_exp_f32 v44, v44
  v_exp_f32 v45, v45
  v_exp_f32 v46, v46
  v_exp_f32 v47, v47
  v_cvt_pk_bf16_f32 v64, v32, v33
  v_cvt_pk_bf16_f32 v65, v34, v35
  v_cvt_pk_bf16_f32 v66, v36, v37
  v_cvt_pk_bf16_f32 v67, v38, v39
  v_cvt_pk_bf16_f32 v68, v40, v41
  v_cvt_pk_bf16_f32 v69, v42, v43
  v_cvt_pk_bf16_f32 v70, v44, v45
  v_cvt_pk_bf16_f32 v71, v46, v47
  v_mfma_f32_32x32x16_bf16 v[80:95], v[28:31], v[64:67], v[80:95]
  s_nop 0
  v_mfma_f32_32x32x16_bf16 v[80:95], v[140:143], v[68:71], v[80:95]
La_62:
  s_cmp_eq_u32 s64, 0
  s_cbranch_scc1 Ld_64
Lm_63:
  ds_read_b64_tr_b16 v[28:29], v9 offset:0
  ds_read_b64_tr_b16 v[30:31], v9 offset:256
  ds_read_b64_tr_b16 v[140:141], v9 offset:512
  ds_read_b64_tr_b16 v[142:143], v9 offset:768
  ds_read_b128 v[20:23], v8
  v_add_u32 v8, 1024, v8
  s_waitcnt lgkmcnt(0)
  v_mfma_f32_32x32x16_bf16 v[32:47], v[20:23], v[16:19], 0
  v_add_u32 v9, v9, v10
  s_nop 10
  v_sub_f32 v32, v32, v11
  v_sub_f32 v33, v33, v11
  v_sub_f32 v34, v34, v11
  v_sub_f32 v35, v35, v11
  v_sub_f32 v36, v36, v11
  v_sub_f32 v37, v37, v11
  v_sub_f32 v38, v38, v11
  v_sub_f32 v39, v39, v11
  v_sub_f32 v40, v40, v11
  v_sub_f32 v41, v41, v11
  v_sub_f32 v42, v42, v11
  v_sub_f32 v43, v43, v11
  v_sub_f32 v44, v44, v11
  v_sub_f32 v45, v45, v11
  v_sub_f32 v46, v46, v11
  v_sub_f32 v47, v47, v11
  v_exp_f32 v32, v32
  v_exp_f32 v33, v33
  v_exp_f32 v34, v34
  v_exp_f32 v35, v35
  v_exp_f32 v36, v36
  v_exp_f32 v37, v37
  v_exp_f32 v38, v38
  v_exp_f32 v39, v39
  v_exp_f32 v40, v40
  v_exp_f32 v41, v41
  v_exp_f32 v42, v42
  v_exp_f32 v43, v43
  v_exp_f32 v44, v44
  v_exp_f32 v45, v45
  v_exp_f32 v46, v46
  v_exp_f32 v47, v47
  v_cvt_pk_bf16_f32 v64, v32, v33
  v_cvt_pk_bf16_f32 v65, v34, v35
  v_cvt_pk_bf16_f32 v66, v36, v37
  v_cvt_pk_bf16_f32 v67, v38, v39
  v_cvt_pk_bf16_f32 v68, v40, v41
  v_cvt_pk_bf16_f32 v69, v42, v43
  v_cvt_pk_bf16_f32 v70, v44, v45
  v_cvt_pk_bf16_f32 v71, v46, v47
  v_mfma_f32_32x32x16_bf16 v[80:95], v[28:31], v[64:67], v[80:95]
  s_nop 0
  v_mfma_f32_32x32x16_bf16 v[80:95], v[140:143], v[68:71], v[80:95]
  s_sub_u32 s64, s64, 1
  s_cmp_lg_u32 s64, 0
  s_cbranch_scc1 Lm_63
Ld_64:
  ds_read_b64_tr_b16 v[28:29], v9 offset:0
  ds_read_b64_tr_b16 v[30:31], v9 offset:256
  ds_read_b64_tr_b16 v[140:141], v9 offset:512
  ds_read_b64_tr_b16 v[142:143], v9 offset:768
  ds_read_b128 v[20:23], v8
  v_add_u32 v8, 1024, v8
  s_waitcnt lgkmcnt(0)
  v_mfma_f32_32x32x16_bf16 v[32:47], v[20:23], v[16:19], v[96:111]
  v_add_u32 v9, v9, v10
  s_nop 10
  v_sub_f32 v32, v32, v11
  v_sub_f32 v33, v33, v11
  v_sub_f32 v34, v34, v11
  v_sub_f32 v35, v35, v11
  v_sub_f32 v36, v36, v11
  v_sub_f32 v37, v37, v11
  v_sub_f32 v38, v38, v11
  v_sub_f32 v39, v39, v11
  v_sub_f32 v40, v40, v11
  v_sub_f32 v41, v41, v11
  v_sub_f32 v42, v42, v11
  v_sub_f32 v43, v43, v11
  v_sub_f32 v44, v44, v11
  v_sub_f32 v45, v45, v11
  v_sub_f32 v46, v46, v11
  v_sub_f32 v47, v47, v11
  v_exp_f32 v32, v32
  v_exp_f32 v33, v33
  v_exp_f32 v34, v34
  v_exp_f32 v35, v35
  v_exp_f32 v36, v36
  v_exp_f32 v37, v37
  v_exp_f32 v38, v38
  v_exp_f32 v39, v39
  v_exp_f32 v40, v40
  v_exp_f32 v41, v41
  v_exp_f32 v42, v42
  v_exp_f32 v43, v43
  v_exp_f32 v44, v44
  v_exp_f32 v45, v45
  v_exp_f32 v46, v46
  v_exp_f32 v47, v47
  v_cvt_pk_bf16_f32 v64, v32, v33
  v_cvt_pk_bf16_f32 v65, v34, v35
  v_cvt_pk_bf16_f32 v66, v36, v37
  v_cvt_pk_bf16_f32 v67, v38, v39
  v_cvt_pk_bf16_f32 v68, v40, v41
  v_cvt_pk_bf16_f32 v69, v42, v43
  v_cvt_pk_bf16_f32 v70, v44, v45
  v_cvt_pk_bf16_f32 v71, v46, v47
  v_mfma_f32_32x32x16_bf16 v[80:95], v[28:31], v[64:67], v[80:95]
  s_nop 0
  v_mfma_f32_32x32x16_bf16 v[80:95], v[140:143], v[68:71], v[80:95]
Ladone_57:
  s_setprio 0
  s_nop 10
  v_rcp_f32 v8, v88
  s_nop 0
  v_pk_mul_f32 v[80:81], v[80:81], v[8:9] op_sel_hi:[1,0]
  v_pk_mul_f32 v[82:83], v[82:83], v[8:9] op_sel_hi:[1,0]
  v_pk_mul_f32 v[84:85], v[84:85], v[8:9] op_sel_hi:[1,0]
  v_pk_mul_f32 v[86:87], v[86:87], v[8:9] op_sel_hi:[1,0]
  v_cvt_pk_bf16_f32 v16, v80, v81
  v_cvt_pk_bf16_f32 v17, v82, v83
  v_cvt_pk_bf16_f32 v18, v84, v85
  v_cvt_pk_bf16_f32 v19, v86, v87
  s_cmp_eq_u32 s45, 0
  s_cbranch_scc1 Lgs_65
  buffer_store_dwordx4 v[16:19], v2, s[24:27], s55 offen
  s_branch Lgsd_66
Lgs_65:
  buffer_store_dwordx4 v[16:19], v2, s[24:27], s55 offen sc1
Lgsd_66:
  s_waitcnt vmcnt(0)
  s_mov_b64 exec, 1
  v_mov_b32 v14, s43
  v_mov_b32 v15, 0
  s_cmp_eq_u32 s45, 0
  s_cbranch_scc1 Lgs_67
  buffer_store_dword v14, v15, s[24:27], s56 offen
  s_branch Lgsd_68
Lgs_67:
  buffer_store_dword v14, v15, s[24:27], s56 offen sc1
Lgsd_68:
  s_mov_b64 exec, -1
  s_barrier
  s_cmp_ge_u32 s42, 4
  s_cbranch_scc1 L_wo_h
  s_lshr_b32 s50, s41, 3
  s_and_b32 s51, s42, 1
  s_lshl_b32 s50, s50, 1
  s_add_u32 s50, s50, s51
  s_lshl_b32 s82, s40, 3
  s_add_u32 s82, s82, s50
  s_lshr_b32 s51, s42, 1
  s_and_b32 s52, s41, 7
  s_lshl_b32 s52, s52, 1
  s_add_u32 s52, s52, s51
  s_lshl_b32 s66, s82, 15
  s_lshl_b32 s83, s52, 11
  s_add_u32 s66, s66, s83
  s_lshr_b32 s69, s52, 2
  s_and_b32 s70, s52, 3
  s_lshl_b32 s67, s82, 12
  s_lshl_b32 s83, s69, 10
  s_add_u32 s67, s67, s83
  s_lshl_b32 s83, s70, 2
  s_add_u32 s67, s67, s83
  s_add_u32 s67, s67, 8388608
  s_lshl_b32 s68, s82, 4
  s_add_u32 s68, s68, s52
  s_lshl_b32 s68, s68, 2
  s_add_u32 s68, s68, s46
  s_add_u32 s68, s68, 13910016
  s_lshl_b32 s69, s42, 12
  s_add_u32 s69, s69, 79872
  v_add_u32 v114, s69, v2
  s_xor_b32 s69, s42, 2
  s_lshl_b32 s69, s69, 12
  s_add_u32 s69, s69, 79872
  v_add_u32 v115, s69, v2
  v_lshlrev_b32 v8, 5, v5
  v_add_u32 v8, v6, v8
  s_lshl_b32 s56, s51, 15
  s_add_u32 s56, s56, 98304
  v_add_u32 v8, s56, v8
  s_lshl_b32 s57, s51, 6
  v_xor_b32 v9, s57, v8
  v_xor_b32 v10, 64, v9
  s_lshl_b32 s57, s51, 12
  v_mul_u32_u24 v12, s57, v5
  v_sub_u32 v11, v9, v12
  v_sub_u32 v12, v10, v12
  s_lshl_b32 s59, s82, 7
  s_lshl_b32 s83, s51, 6
  s_add_u32 s59, s59, s83
  s_add_u32 s59, s59, s46
  s_add_u32 s59, s59, 13901824
  s_mul_i32 s61, s82, 98304
  s_mov_b32 s61, s61
  s_lshl_b32 s83, s51, 14
  s_add_u32 s61, s61, s83
  s_add_u32 s61, s61, 2097152
  v_and_b32 v14, 15, v1
  v_lshlrev_b32 v14, 2, v14
  s_mov_b32 s79, 262144
  buffer_load_dword v15, v14, s[24:27], s59 offen sc1
  v_lshlrev_b32 v80, 16, v72
  v_and_b32 v81, 0xffff0000, v72
  v_lshlrev_b32 v82, 16, v73
  v_and_b32 v83, 0xffff0000, v73
  v_lshlrev_b32 v84, 16, v74
  v_and_b32 v85, 0xffff0000, v74
  v_lshlrev_b32 v86, 16, v75
  v_and_b32 v87, 0xffff0000, v75
  v_lshlrev_b32 v88, 16, v76
  v_and_b32 v89, 0xffff0000, v76
  v_lshlrev_b32 v90, 16, v77
  v_and_b32 v91, 0xffff0000, v77
  v_lshlrev_b32 v92, 16, v78
  v_and_b32 v93, 0xffff0000, v78
  v_lshlrev_b32 v94, 16, v79
  v_and_b32 v95, 0xffff0000, v79
  s_waitcnt vmcnt(0)
  v_cmp_ne_u32 vcc, s43, v15
  s_cbranch_vccz Lpolld_70
Lpoll_69:
  buffer_load_dword v15, v14, s[24:27], s59 offen sc1
  s_sub_u32 s79, s79, 1
  s_cbranch_scc1 Lpolld_70
  s_waitcnt vmcnt(0)
  v_cmp_ne_u32 vcc, s43, v15
  s_cbranch_vccnz Lpoll_69
Lpolld_70:
  s_waitcnt vmcnt(0)
  buffer_load_dwordx4 v[128:131], v2, s[24:27], s61 offen offset:0 sc1
  buffer_load_dwordx4 v[132:135], v2, s[24:27], s61 offen offset:1024 sc1
  buffer_load_dwordx4 v[136:139], v2, s[24:27], s61 offen offset:2048 sc1
  buffer_load_dwordx4 v[140:143], v2, s[24:27], s61 offen offset:3072 sc1
  s_add_u32 s61, s61, 4096
  buffer_load_dwordx4 v[144:147], v2, s[24:27], s61 offen offset:0 sc1
  buffer_load_dwordx4 v[148:151], v2, s[24:27], s61 offen offset:1024 sc1
  buffer_load_dwordx4 v[152:155], v2, s[24:27], s61 offen offset:2048 sc1
  buffer_load_dwordx4 v[156:159], v2, s[24:27], s61 offen offset:3072 sc1
  s_add_u32 s61, s61, 4096
  ds_read_b64_tr_b16 v[56:57], v9 offset:0
  ds_read_b64_tr_b16 v[58:59], v9 offset:512
  ds_read_b64_tr_b16 v[60:61], v10 offset:0
  ds_read_b64_tr_b16 v[62:63], v10 offset:512
  s_waitcnt vmcnt(7)
  s_waitcnt lgkmcnt(2)
  v_mfma_f32_32x32x16_bf16 v[80:95], v[56:59], v[128:131], v[80:95]
  ds_read_b64_tr_b16 v[64:65], v9 offset:2048
  ds_read_b64_tr_b16 v[66:67], v9 offset:2560
  buffer_load_dwordx4 v[160:163], v2, s[24:27], s61 offen offset:0 sc1
  s_waitcnt lgkmcnt(2)
  v_mfma_f32_32x32x16_bf16 v[96:111], v[60:63], v[128:131], 0
  ds_read_b64_tr_b16 v[68:69], v10 offset:2048
  ds_read_b64_tr_b16 v[70:71], v10 offset:2560
  s_waitcnt vmcnt(7)
  s_waitcnt lgkmcnt(2)
  v_mfma_f32_32x32x16_bf16 v[80:95], v[64:67], v[132:135], v[80:95]
  ds_read_b64_tr_b16 v[56:57], v9 offset:4096
  ds_read_b64_tr_b16 v[58:59], v9 offset:4608
  buffer_load_dwordx4 v[164:167], v2, s[24:27], s61 offen offset:1024 sc1
  s_waitcnt lgkmcnt(2)
  v_mfma_f32_32x32x16_bf16 v[96:111], v[68:71], v[132:135], v[96:111]
  ds_read_b64_tr_b16 v[60:61], v10 offset:4096
  ds_read_b64_tr_b16 v[62:63], v10 offset:4608
  s_waitcnt vmcnt(7)
  s_waitcnt lgkmcnt(2)
  v_mfma_f32_32x32x16_bf16 v[80:95], v[56:59], v[136:139], v[80:95]
  ds_read_b64_tr_b16 v[64:65], v9 offset:6144
  ds_read_b64_tr_b16 v[66:67], v9 offset:6656
  buffer_load_dwordx4 v[168:171], v2, s[24:27], s61 offen offset:2048 sc1
  s_waitcnt lgkmcnt(2)
  v_mfma_f32_32x32x16_bf16 v[96:111], v[60:63], v[136:139], v[96:111]
  ds_read_b64_tr_b16 v[68:69], v10 offset:6144
  ds_read_b64_tr_b16 v[70:71], v10 offset:6656
  s_waitcnt vmcnt(7)
  s_waitcnt lgkmcnt(2)
  v_mfma_f32_32x32x16_bf16 v[80:95], v[64:67], v[140:143], v[80:95]
  ds_read_b64_tr_b16 v[56:57], v9 offset:8192
  ds_read_b64_tr_b16 v[58:59], v9 offset:8704
  buffer_load_dwordx4 v[172:175], v2, s[24:27], s61 offen offset:3072 sc1
  s_add_u32 s61, s61, 4096
  s_waitcnt lgkmcnt(2)
  v_mfma_f32_32x32x16_bf16 v[96:111], v[68:71], v[140:143], v[96:111]
  ds_read_b64_tr_b16 v[60:61], v10 offset:8192
  ds_read_b64_tr_b16 v[62:63], v10 offset:8704
  s_waitcnt vmcnt(7)
  s_waitcnt lgkmcnt(2)
  v_mfma_f32_32x32x16_bf16 v[80:95], v[56:59], v[144:147], v[80:95]
  ds_read_b64_tr_b16 v[64:65], v9 offset:10240
  ds_read_b64_tr_b16 v[66:67], v9 offset:10752
  buffer_load_dwordx4 v[176:179], v2, s[24:27], s61 offen offset:0 sc1
  s_waitcnt lgkmcnt(2)
  v_mfma_f32_32x32x16_bf16 v[96:111], v[60:63], v[144:147], v[96:111]
  ds_read_b64_tr_b16 v[68:69], v10 offset:10240
  ds_read_b64_tr_b16 v[70:71], v10 offset:10752
  s_waitcnt vmcnt(7)
  s_waitcnt lgkmcnt(2)
  v_mfma_f32_32x32x16_bf16 v[80:95], v[64:67], v[148:151], v[80:95]
  ds_read_b64_tr_b16 v[56:57], v9 offset:12288
  ds_read_b64_tr_b16 v[58:59], v9 offset:12800
  buffer_load_dwordx4 v[180:183], v2, s[24:27], s61 offen offset:1024 sc1
  s_waitcnt lgkmcnt(2)
  v_mfma_f32_32x32x16_bf16 v[96:111], v[68:71], v[148:151], v[96:111]
  ds_read_b64_tr_b16 v[60:61], v10 offset:12288
  ds_read_b64_tr_b16 v[62:63], v10 offset:12800
  s_waitcnt vmcnt(7)
  s_waitcnt lgkmcnt(2)
  v_mfma_f32_32x32x16_bf16 v[80:95], v[56:59], v[152:155], v[80:95]
  ds_read_b64_tr_b16 v[64:65], v9 offset:14336
  ds_read_b64_tr_b16 v[66:67], v9 offset:14848
  buffer_load_dwordx4 v[184:187], v2, s[24:27], s61 offen offset:2048 sc1
  s_waitcnt lgkmcnt(2)
  v_mfma_f32_32x32x16_bf16 v[96:111], v[60:63], v[152:155], v[96:111]
  ds_read_b64_tr_b16 v[68:69], v10 offset:14336
  ds_read_b64_tr_b16 v[70:71], v10 offset:14848
  s_waitcnt vmcnt(7)
  s_waitcnt lgkmcnt(2)
  v_mfma_f32_32x32x16_bf16 v[80:95], v[64:67], v[156:159], v[80:95]
  ds_read_b64_tr_b16 v[56:57], v9 offset:16384
  ds_read_b64_tr_b16 v[58:59], v9 offset:16896
  buffer_load_dwordx4 v[188:191], v2, s[24:27], s61 offen offset:3072 sc1
  s_add_u32 s61, s61, 4096
  s_waitcnt lgkmcnt(2)
  v_mfma_f32_32x32x16_bf16 v[96:111], v[68:71], v[156:159], v[96:111]
  ds_read_b64_tr_b16 v[60:61], v10 offset:16384
  ds_read_b64_tr_b16 v[62:63], v10 offset:16896
  s_waitcnt vmcnt(7)
  s_waitcnt lgkmcnt(2)
  v_mfma_f32_32x32x16_bf16 v[80:95], v[56:59], v[160:163], v[80:95]
  ds_read_b64_tr_b16 v[64:65], v9 offset:18432
  ds_read_b64_tr_b16 v[66:67], v9 offset:18944
  s_waitcnt lgkmcnt(2)
  v_mfma_f32_32x32x16_bf16 v[96:111], v[60:63], v[160:163], v[96:111]
  ds_read_b64_tr_b16 v[68:69], v10 offset:18432
  ds_read_b64_tr_b16 v[70:71], v10 offset:18944
  s_waitcnt vmcnt(6)
  s_waitcnt lgkmcnt(2)
  v_mfma_f32_32x32x16_bf16 v[80:95], v[64:67], v[164:167], v[80:95]
  ds_read_b64_tr_b16 v[56:57], v9 offset:20480
  ds_read_b64_tr_b16 v[58:59], v9 offset:20992
  s_waitcnt lgkmcnt(2)
  v_mfma_f32_32x32x16_bf16 v[96:111], v[68:71], v[164:167], v[96:111]
  ds_read_b64_tr_b16 v[60:61], v10 offset:20480
  ds_read_b64_tr_b16 v[62:63], v10 offset:20992
  s_waitcnt vmcnt(5)
  s_waitcnt lgkmcnt(2)
  v_mfma_f32_32x32x16_bf16 v[80:95], v[56:59], v[168:171], v[80:95]
  ds_read_b64_tr_b16 v[64:65], v9 offset:22528
  ds_read_b64_tr_b16 v[66:67], v9 offset:23040
  s_waitcnt lgkmcnt(2)
  v_mfma_f32_32x32x16_bf16 v[96:111], v[60:63], v[168:171], v[96:111]
  ds_read_b64_tr_b16 v[68:69], v10 offset:22528
  ds_read_b64_tr_b16 v[70:71], v10 offset:23040
  s_waitcnt vmcnt(4)
  s_waitcnt lgkmcnt(2)
  v_mfma_f32_32x32x16_bf16 v[80:95], v[64:67], v[172:175], v[80:95]
  ds_read_b64_tr_b16 v[56:57], v9 offset:24576
  ds_read_b64_tr_b16 v[58:59], v9 offset:25088
  s_waitcnt lgkmcnt(2)
  v_mfma_f32_32x32x16_bf16 v[96:111], v[68:71], v[172:175], v[96:111]
  ds_read_b64_tr_b16 v[60:61], v10 offset:24576
  ds_read_b64_tr_b16 v[62:63], v10 offset:25088
  s_waitcnt vmcnt(3)
  s_waitcnt lgkmcnt(2)
  v_mfma_f32_32x32x16_bf16 v[80:95], v[56:59], v[176:179], v[80:95]
  ds_read_b64_tr_b16 v[64:65], v9 offset:26624
  ds_read_b64_tr_b16 v[66:67], v9 offset:27136
  s_waitcnt lgkmcnt(2)
  v_mfma_f32_32x32x16_bf16 v[96:111], v[60:63], v[176:179], v[96:111]
  ds_read_b64_tr_b16 v[68:69], v10 offset:26624
  ds_read_b64_tr_b16 v[70:71], v10 offset:27136
  s_waitcnt vmcnt(2)
  s_waitcnt lgkmcnt(2)
  v_mfma_f32_32x32x16_bf16 v[80:95], v[64:67], v[180:183], v[80:95]
  ds_read_b64_tr_b16 v[56:57], v9 offset:28672
  ds_read_b64_tr_b16 v[58:59], v9 offset:29184
  s_waitcnt lgkmcnt(2)
  v_mfma_f32_32x32x16_bf16 v[96:111], v[68:71], v[180:183], v[96:111]
  ds_read_b64_tr_b16 v[60:61], v10 offset:28672
  ds_read_b64_tr_b16 v[62:63], v10 offset:29184
  s_waitcnt vmcnt(1)
  s_waitcnt lgkmcnt(2)
  v_mfma_f32_32x32x16_bf16 v[80:95], v[56:59], v[184:187], v[80:95]
  ds_read_b64_tr_b16 v[64:65], v11 offset:30720
  ds_read_b64_tr_b16 v[66:67], v11 offset:31232
  s_waitcnt lgkmcnt(2)
  v_mfma_f32_32x32x16_bf16 v[96:111], v[60:63], v[184:187], v[96:111]
  ds_read_b64_tr_b16 v[68:69], v12 offset:30720
  ds_read_b64_tr_b16 v[70:71], v12 offset:31232
  s_waitcnt vmcnt(0)
  s_waitcnt lgkmcnt(2)
  v_mfma_f32_32x32x16_bf16 v[80:95], v[64:67], v[188:191], v[80:95]
  s_waitcnt lgkmcnt(0)
  v_mfma_f32_32x32x16_bf16 v[96:111], v[68:71], v[188:191], v[96:111]
  s_nop 11
  ds_write_b128 v114, v[96:99] offset:0
  ds_write_b128 v114, v[100:103] offset:1024
  ds_write_b128 v114, v[104:107] offset:2048
  ds_write_b128 v114, v[108:111] offset:3072
  s_waitcnt lgkmcnt(0)
  s_barrier
  ds_read_b128 v[32:35], v115 offset:0
  ds_read_b128 v[36:39], v115 offset:1024
  ds_read_b128 v[40:43], v115 offset:2048
  ds_read_b128 v[44:47], v115 offset:3072
  s_waitcnt lgkmcnt(3)
  v_pk_add_f32 v[80:81], v[80:81], v[32:33]
  v_pk_add_f32 v[82:83], v[82:83], v[34:35]
  s_waitcnt lgkmcnt(2)
  v_pk_add_f32 v[84:85], v[84:85], v[36:37]
  v_pk_add_f32 v[86:87], v[86:87], v[38:39]
  s_waitcnt lgkmcnt(1)
  v_pk_add_f32 v[88:89], v[88:89], v[40:41]
  v_pk_add_f32 v[90:91], v[90:91], v[42:43]
  s_waitcnt lgkmcnt(0)
  v_pk_add_f32 v[92:93], v[92:93], v[44:45]
  v_pk_add_f32 v[94:95], v[94:95], v[46:47]
  v_cvt_pk_bf16_f32 v72, v80, v81
  v_cvt_pk_bf16_f32 v73, v82, v83
  v_cvt_pk_bf16_f32 v74, v84, v85
  v_cvt_pk_bf16_f32 v75, v86, v87
  v_cvt_pk_bf16_f32 v76, v88, v89
  v_cvt_pk_bf16_f32 v77, v90, v91
  v_cvt_pk_bf16_f32 v78, v92, v93
  v_cvt_pk_bf16_f32 v79, v94, v95
  s_cmp_eq_u32 s45, 0
  s_cbranch_scc1 Lgs_71
  buffer_store_dwordx4 v[72:75], v2, s[24:27], s66 offen
  buffer_store_dwordx4 v[76:79], v2, s[24:27], s66 offen offset:1024
  s_branch Lgsd_72
Lgs_71:
  buffer_store_dwordx4 v[72:75], v2, s[24:27], s66 offen sc1
  buffer_store_dwordx4 v[76:79], v2, s[24:27], s66 offen offset:1024 sc1
Lgsd_72:
  v_pk_mul_f32 v[10:11], v[80:81], v[80:81]
  v_pk_add_f32 v[8:9], v[80:81], v[82:83]
  v_pk_fma_f32 v[10:11], v[82:83], v[82:83], v[10:11]
  v_pk_add_f32 v[8:9], v[8:9], v[84:85]
  v_pk_fma_f32 v[10:11], v[84:85], v[84:85], v[10:11]
  v_pk_add_f32 v[8:9], v[8:9], v[86:87]
  v_pk_fma_f32 v[10:11], v[86:87], v[86:87], v[10:11]
  v_pk_add_f32 v[8:9], v[8:9], v[88:89]
  v_pk_fma_f32 v[10:11], v[88:89], v[88:89], v[10:11]
  v_pk_add_f32 v[8:9], v[8:9], v[90:91]
  v_pk_fma_f32 v[10:11], v[90:91], v[90:91], v[10:11]
  v_pk_add_f32 v[8:9], v[8:9], v[92:93]
  v_pk_fma_f32 v[10:11], v[92:93], v[92:93], v[10:11]
  v_pk_add_f32 v[8:9], v[8:9], v[94:95]
  v_pk_fma_f32 v[10:11], v[94:95], v[94:95], v[10:11]
  v_add_f32 v8, v8, v9
  v_add_f32 v10, v10, v11
  s_nop 1
  v_permlane32_swap_b32 v8, v10
  v_add_f32 v8, v8, v10
  s_cmp_eq_u32 s45, 0
  s_cbranch_scc1 Lgs_73
  buffer_store_dword v8, v2, s[24:27], s67 offen
  s_branch Lgsd_74
Lgs_73:
  buffer_store_dword v8, v2, s[24:27], s67 offen sc1
Lgsd_74:
  s_waitcnt vmcnt(0)
  s_mov_b64 exec, 1
  v_mov_b32 v14, s43
  v_mov_b32 v15, 0
  s_cmp_eq_u32 s45, 0
  s_cbranch_scc1 Lgs_75
  buffer_store_dword v14, v15, s[24:27], s68 offen
  s_branch Lgsd_76
Lgs_75:
  buffer_store_dword v14, v15, s[24:27], s68 offen sc1
Lgsd_76:
  s_mov_b64 exec, -1
  s_barrier
  s_branch L_wo_d
L_wo_h:
  v_lshrrev_b32 v14, 3, v1
  v_mul_u32_u24 v14, 2752, v14
  v_bfe_u32 v15, v1, 4, 1
  v_lshlrev_b32 v15, 2, v15
  v_xor_b32 v15, v15, v1
  v_and_b32 v15, 7, v15
  v_lshl_add_u32 v8, v15, 4, v14
  s_lshr_b32 s70, s41, 1
  s_mul_i32 s71, s70, 3
  s_lshl_b32 s72, s70, 1
  s_add_u32 s72, s72, 11
  s_cmp_lt_u32 s70, 11
  s_cselect_b32 s60, s71, s72
  s_min_u32 s60, s60, 42
  s_sub_u32 s50, s42, 4
  s_add_u32 s51, s50, 30
  s_mul_i32 s62, s51, 22016
  s_lshl_b32 s60, s60, 6
  s_add_u32 s60, s60, s62
  s_lshl_b32 s62, s51, 10
  s_add_u32 s62, s62, 32768
  s_and_b32 s53, s41, 1
  s_lshl_b32 s53, s53, 1
  s_and_b32 s53, s53, 3
  s_mov_b32 s73, s53
  s_mul_i32 s74, s73, 88064
  s_mul_i32 s75, s73, 4096
  s_add_u32 s74, s74, s60
  s_add_u32 s75, s75, s62
  s_mov_b32 m0, s75
  s_add_u32 s73, s73, 1
  buffer_load_dwordx4 v8, s[16:19], s74 offen lds
  s_cmp_eq_u32 s73, 4
  s_cselect_b32 s73, 0, s73
  s_mul_i32 s74, s73, 88064
  s_mul_i32 s75, s73, 4096
  s_add_u32 s74, s74, s60
  s_add_u32 s75, s75, s62
  s_mov_b32 m0, s75
  s_add_u32 s73, s73, 1
  buffer_load_dwordx4 v8, s[16:19], s74 offen lds
  s_cmp_eq_u32 s73, 4
  s_cselect_b32 s73, 0, s73
  s_mul_i32 s74, s73, 88064
  s_mul_i32 s75, s73, 4096
  s_add_u32 s74, s74, s60
  s_add_u32 s75, s75, s62
  s_mov_b32 m0, s75
  s_add_u32 s73, s73, 1
  buffer_load_dwordx4 v8, s[16:19], s74 offen lds
  s_cmp_eq_u32 s73, 4
  s_cselect_b32 s73, 0, s73
  s_mul_i32 s74, s73, 88064
  s_mul_i32 s75, s73, 4096
  s_add_u32 s74, s74, s60
  s_add_u32 s75, s75, s62
  s_mov_b32 m0, s75
  s_add_u32 s73, s73, 1
  buffer_load_dwordx4 v8, s[16:19], s74 offen lds
  s_add_u32 s60, s60, 352256
  s_add_u32 s62, s62, 16384
  s_barrier
  s_barrier
  s_mov_b32 s73, s53
  s_mul_i32 s74, s73, 88064
  s_mul_i32 s75, s73, 4096
  s_add_u32 s74, s74, s60
  s_add_u32 s75, s75, s62
  s_mov_b32 m0, s75
  s_add_u32 s73, s73, 1
  buffer_load_dwordx4 v8, s[16:19], s74 offen lds
  s_cmp_eq_u32 s73, 4
  s_cselect_b32 s73, 0, s73
  s_mul_i32 s74, s73, 88064
  s_mul_i32 s75, s73, 4096
  s_add_u32 s74, s74, s60
  s_add_u32 s75, s75, s62
  s_mov_b32 m0, s75
  s_add_u32 s73, s73, 1
  buffer_load_dwordx4 v8, s[16:19], s74 offen lds
  s_cmp_eq_u32 s73, 4
  s_cselect_b32 s73, 0, s73
  s_mul_i32 s74, s73, 88064
  s_mul_i32 s75, s73, 4096
  s_add_u32 s74, s74, s60
  s_add_u32 s75, s75, s62
  s_mov_b32 m0, s75
  s_add_u32 s73, s73, 1
  buffer_load_dwordx4 v8, s[16:19], s74 offen lds
  s_cmp_eq_u32 s73, 4
  s_cselect_b32 s73, 0, s73
  s_mul_i32 s74, s73, 88064
  s_mul_i32 s75, s73, 4096
  s_add_u32 s74, s74, s60
  s_add_u32 s75, s75, s62
  s_mov_b32 m0, s75
  s_add_u32 s73, s73, 1
  buffer_load_dwordx4 v8, s[16:19], s74 offen lds
  s_cmp_ge_u32 s50, 2
  s_cbranch_scc1 Lw1x_77
  s_add_u32 s60, s60, 352256
  s_add_u32 s62, s62, 16384
  s_mov_b32 m0, s62
  s_add_u32 s62, s62, 1024
  buffer_load_dwordx4 v8, s[16:19], s60 offen lds
  s_add_u32 s60, s60, 0
Lw1x_77:
L_wo_d:
  s_cmp_ge_u32 s42, 4
  s_cbranch_scc1 L_mlp1_h
  s_and_b32 s50, s41, 1
  s_lshl_b32 s50, s50, 2
  s_add_u32 s50, s50, s42
  s_lshl_b32 s82, s40, 3
  s_add_u32 s82, s82, s50
  s_lshr_b32 s52, s41, 1
  s_lshl_b32 s53, s82, 6
  s_add_u32 s53, s53, s46
  s_add_u32 s53, s53, 13910016
  s_mul_i32 s55, s82, 98304
  s_add_u32 s55, s55, 2097152
  s_lshl_b32 s56, s82, 15
  s_lshl_b32 s57, s82, 12
  s_add_u32 s57, s57, 8388608
  v_add_u32 v10, 32768, v6
  v_xor_b32 v11, 64, v10
  v_add_u32 v13, 162816, v5
  s_lshl_b32 s64, s82, 4
  s_add_u32 s64, s64, s52
  s_lshl_b32 s64, s64, 2
  s_add_u32 s64, s64, s46
  s_add_u32 s64, s64, 13918208
  s_lshr_b32 s70, s41, 1
  s_mul_i32 s71, s70, 3
  s_lshl_b32 s72, s70, 1
  s_add_u32 s72, s72, 11
  s_cmp_lt_u32 s70, 11
  s_cselect_b32 s58, s71, s72
  s_min_u32 s58, s58, 42
  s_lshl_b32 s58, s58, 11
  s_add_u32 s58, s58, s55
  v_and_b32 v14, 15, v1
  v_lshlrev_b32 v14, 2, v14
  s_mov_b32 s79, 262144
Lpoll_78:
  buffer_load_dword v15, v14, s[24:27], s53 offen sc1
  s_sub_u32 s79, s79, 1
  s_cbranch_scc1 Lpolld_79
  s_waitcnt vmcnt(0)
  v_cmp_ne_u32 vcc, s43, v15
  s_cbranch_vccnz Lpoll_78
Lpolld_79:
  s_waitcnt vmcnt(0)
  buffer_load_dwordx4 v[128:131], v2, s[24:27], s56 offen offset:0 sc1
  buffer_load_dwordx4 v[132:135], v2, s[24:27], s56 offen offset:1024 sc1
  buffer_load_dwordx4 v[136:139], v2, s[24:27], s56 offen offset:2048 sc1
  buffer_load_dwordx4 v[140:143], v2, s[24:27], s56 offen offset:3072 sc1
  s_add_u32 s56, s56, 4096
  buffer_load_dwordx4 v[144:147], v2, s[24:27], s56 offen offset:0 sc1
  buffer_load_dwordx4 v[148:151], v2, s[24:27], s56 offen offset:1024 sc1
  buffer_load_dwordx4 v[152:155], v2, s[24:27], s56 offen offset:2048 sc1
  buffer_load_dwordx4 v[156:159], v2, s[24:27], s56 offen offset:3072 sc1
  s_add_u32 s56, s56, 4096
  s_or_b32 s70, s41, s42
  s_or_b32 s70, s70, s47
  s_cmp_lg_u32 s70, 0
  s_cbranch_scc1 Lep_80
  s_cmp_eq_u32 s40, 0
  s_cbranch_scc1 Lep2_81
  s_lshl_b32 s70, s40, 8
  s_add_u32 s70, s70, 18874112
  s_mov_b64 exec, 1
  v_mov_b32 v14, s44
  v_mov_b32 v15, 0
  buffer_store_dword v14, v15, s[24:27], s70 offen sc1
  s_mov_b64 exec, -1
Lep2_81:
  s_cmp_lg_u32 s40, 7
  s_cbranch_scc1 Lep_80
  s_mov_b32 s70, 18876160
  s_mov_b64 exec, 1
  v_mov_b32 v14, s43
  v_mov_b32 v15, 0
  buffer_store_dword v14, v15, s[24:27], s70 offen sc1
  s_mov_b64 exec, -1
Lep_80:
  s_waitcnt lgkmcnt(0)
  s_barrier
  ds_read_b64_tr_b16 v[56:57], v10 offset:0
  ds_read_b64_tr_b16 v[58:59], v10 offset:1024
  ds_read_b64_tr_b16 v[60:61], v11 offset:0
  ds_read_b64_tr_b16 v[62:63], v11 offset:1024
  s_waitcnt vmcnt(7)
  s_waitcnt lgkmcnt(2)
  v_mfma_f32_32x32x16_bf16 v[96:111], v[56:59], v[128:131], 0
  ds_read_b64_tr_b16 v[64:65], v10 offset:2048
  ds_read_b64_tr_b16 v[66:67], v10 offset:3072
  buffer_load_dwordx4 v[160:163], v2, s[24:27], s56 offen offset:0 sc1
  s_waitcnt lgkmcnt(2)
  v_mfma_f32_32x32x16_bf16 v[112:127], v[60:63], v[128:131], 0
  ds_read_b64_tr_b16 v[68:69], v11 offset:2048
  ds_read_b64_tr_b16 v[70:71], v11 offset:3072
  s_waitcnt vmcnt(7)
  s_waitcnt lgkmcnt(2)
  v_mfma_f32_32x32x16_bf16 v[96:111], v[64:67], v[132:135], v[96:111]
  ds_read_b64_tr_b16 v[56:57], v10 offset:4096
  ds_read_b64_tr_b16 v[58:59], v10 offset:5120
  buffer_load_dwordx4 v[164:167], v2, s[24:27], s56 offen offset:1024 sc1
  s_waitcnt lgkmcnt(2)
  v_mfma_f32_32x32x16_bf16 v[112:127], v[68:71], v[132:135], v[112:127]
  ds_read_b64_tr_b16 v[60:61], v11 offset:4096
  ds_read_b64_tr_b16 v[62:63], v11 offset:5120
  s_waitcnt vmcnt(7)
  s_waitcnt lgkmcnt(2)
  v_mfma_f32_32x32x16_bf16 v[96:111], v[56:59], v[136:139], v[96:111]
  ds_read_b64_tr_b16 v[64:65], v10 offset:6144
  ds_read_b64_tr_b16 v[66:67], v10 offset:7168
  buffer_load_dwordx4 v[168:171], v2, s[24:27], s56 offen offset:2048 sc1
  s_waitcnt lgkmcnt(2)
  v_mfma_f32_32x32x16_bf16 v[112:127], v[60:63], v[136:139], v[112:127]
  ds_read_b64_tr_b16 v[68:69], v11 offset:6144
  ds_read_b64_tr_b16 v[70:71], v11 offset:7168
  s_waitcnt vmcnt(7)
  s_waitcnt lgkmcnt(2)
  v_mfma_f32_32x32x16_bf16 v[96:111], v[64:67], v[140:143], v[96:111]
  ds_read_b64_tr_b16 v[56:57], v10 offset:8192
  ds_read_b64_tr_b16 v[58:59], v10 offset:9216
  buffer_load_dwordx4 v[172:175], v2, s[24:27], s56 offen offset:3072 sc1
  s_add_u32 s56, s56, 4096
  s_waitcnt lgkmcnt(2)
  v_mfma_f32_32x32x16_bf16 v[112:127], v[68:71], v[140:143], v[112:127]
  ds_read_b64_tr_b16 v[60:61], v11 offset:8192
  ds_read_b64_tr_b16 v[62:63], v11 offset:9216
  s_waitcnt vmcnt(7)
  s_waitcnt lgkmcnt(2)
  v_mfma_f32_32x32x16_bf16 v[96:111], v[56:59], v[144:147], v[96:111]
  ds_read_b64_tr_b16 v[64:65], v10 offset:10240
  ds_read_b64_tr_b16 v[66:67], v10 offset:11264
  buffer_load_dwordx4 v[176:179], v2, s[24:27], s56 offen offset:0 sc1
  s_waitcnt lgkmcnt(2)
  v_mfma_f32_32x32x16_bf16 v[112:127], v[60:63], v[144:147], v[112:127]
  ds_read_b64_tr_b16 v[68:69], v11 offset:10240
  ds_read_b64_tr_b16 v[70:71], v11 offset:11264
  s_waitcnt vmcnt(7)
  s_waitcnt lgkmcnt(2)
  v_mfma_f32_32x32x16_bf16 v[96:111], v[64:67], v[148:151], v[96:111]
  ds_read_b64_tr_b16 v[56:57], v10 offset:12288
  ds_read_b64_tr_b16 v[58:59], v10 offset:13312
  buffer_load_dwordx4 v[180:183], v2, s[24:27], s56 offen offset:1024 sc1
  s_waitcnt lgkmcnt(2)
  v_mfma_f32_32x32x16_bf16 v[112:127], v[68:71], v[148:151], v[112:127]
  ds_read_b64_tr_b16 v[60:61], v11 offset:12288
  ds_read_b64_tr_b16 v[62:63], v11 offset:13312
  s_waitcnt vmcnt(7)
  s_waitcnt lgkmcnt(2)
  v_mfma_f32_32x32x16_bf16 v[96:111], v[56:59], v[152:155], v[96:111]
  ds_read_b64_tr_b16 v[64:65], v10 offset:14336
  ds_read_b64_tr_b16 v[66:67], v10 offset:15360
  buffer_load_dwordx4 v[184:187], v2, s[24:27], s56 offen offset:2048 sc1
  s_waitcnt lgkmcnt(2)
  v_mfma_f32_32x32x16_bf16 v[112:127], v[60:63], v[152:155], v[112:127]
  ds_read_b64_tr_b16 v[68:69], v11 offset:14336
  ds_read_b64_tr_b16 v[70:71], v11 offset:15360
  s_waitcnt vmcnt(7)
  s_waitcnt lgkmcnt(2)
  v_mfma_f32_32x32x16_bf16 v[96:111], v[64:67], v[156:159], v[96:111]
  ds_read_b64_tr_b16 v[56:57], v10 offset:16384
  ds_read_b64_tr_b16 v[58:59], v10 offset:17408
  buffer_load_dwordx4 v[188:191], v2, s[24:27], s56 offen offset:3072 sc1
  s_add_u32 s56, s56, 4096
  s_waitcnt lgkmcnt(2)
  v_mfma_f32_32x32x16_bf16 v[112:127], v[68:71], v[156:159], v[112:127]
  ds_read_b64_tr_b16 v[60:61], v11 offset:16384
  ds_read_b64_tr_b16 v[62:63], v11 offset:17408
  s_waitcnt vmcnt(7)
  s_waitcnt lgkmcnt(2)
  v_mfma_f32_32x32x16_bf16 v[96:111], v[56:59], v[160:163], v[96:111]
  ds_read_b64_tr_b16 v[64:65], v10 offset:18432
  ds_read_b64_tr_b16 v[66:67], v10 offset:19456
  buffer_load_dwordx4 v[192:195], v2, s[24:27], s56 offen offset:0 sc1
  s_waitcnt lgkmcnt(2)
  v_mfma_f32_32x32x16_bf16 v[112:127], v[60:63], v[160:163], v[112:127]
  ds_read_b64_tr_b16 v[68:69], v11 offset:18432
  ds_read_b64_tr_b16 v[70:71], v11 offset:19456
  s_waitcnt vmcnt(7)
  s_waitcnt lgkmcnt(2)
  v_mfma_f32_32x32x16_bf16 v[96:111], v[64:67], v[164:167], v[96:111]
  ds_read_b64_tr_b16 v[56:57], v10 offset:20480
  ds_read_b64_tr_b16 v[58:59], v10 offset:21504
  buffer_load_dwordx4 v[196:199], v2, s[24:27], s56 offen offset:1024 sc1
  s_waitcnt lgkmcnt(2)
  v_mfma_f32_32x32x16_bf16 v[112:127], v[68:71], v[164:167], v[112:127]
  ds_read_b64_tr_b16 v[60:61], v11 offset:20480
  ds_read_b64_tr_b16 v[62:63], v11 offset:21504
  s_waitcnt vmcnt(7)
  s_waitcnt lgkmcnt(2)
  v_mfma_f32_32x32x16_bf16 v[96:111], v[56:59], v[168:171], v[96:111]
  ds_read_b64_tr_b16 v[64:65], v10 offset:22528
  ds_read_b64_tr_b16 v[66:67], v10 offset:23552
  buffer_load_dwordx4 v[200:203], v2, s[24:27], s56 offen offset:2048 sc1
  s_waitcnt lgkmcnt(2)
  v_mfma_f32_32x32x16_bf16 v[112:127], v[60:63], v[168:171], v[112:127]
  ds_read_b64_tr_b16 v[68:69], v11 offset:22528
  ds_read_b64_tr_b16 v[70:71], v11 offset:23552
  s_waitcnt vmcnt(7)
  s_waitcnt lgkmcnt(2)
  v_mfma_f32_32x32x16_bf16 v[96:111], v[64:67], v[172:175], v[96:111]
  ds_read_b64_tr_b16 v[56:57], v10 offset:24576
  ds_read_b64_tr_b16 v[58:59], v10 offset:25600
  buffer_load_dwordx4 v[204:207], v2, s[24:27], s56 offen offset:3072 sc1
  s_add_u32 s56, s56, 4096
  s_waitcnt lgkmcnt(2)
  v_mfma_f32_32x32x16_bf16 v[112:127], v[68:71], v[172:175], v[112:127]
  ds_read_b64_tr_b16 v[60:61], v11 offset:24576
  ds_read_b64_tr_b16 v[62:63], v11 offset:25600
  s_waitcnt vmcnt(7)
  s_waitcnt lgkmcnt(2)
  v_mfma_f32_32x32x16_bf16 v[96:111], v[56:59], v[176:179], v[96:111]
  ds_read_b64_tr_b16 v[64:65], v10 offset:26624
  ds_read_b64_tr_b16 v[66:67], v10 offset:27648
  buffer_load_dwordx4 v[208:211], v2, s[24:27], s56 offen offset:0 sc1
  s_waitcnt lgkmcnt(2)
  v_mfma_f32_32x32x16_bf16 v[112:127], v[60:63], v[176:179], v[112:127]
  ds_read_b64_tr_b16 v[68:69], v11 offset:26624
  ds_read_b64_tr_b16 v[70:71], v11 offset:27648
  buffer_load_dwordx4 v[32:35], v2, s[24:27], s57 offen offset:0 sc1
  s_waitcnt vmcnt(8)
  s_waitcnt lgkmcnt(2)
  v_mfma_f32_32x32x16_bf16 v[96:111], v[64:67], v[180:183], v[96:111]
  ds_read_b64_tr_b16 v[56:57], v10 offset:28672
  ds_read_b64_tr_b16 v[58:59], v10 offset:29696
  buffer_load_dwordx4 v[212:215], v2, s[24:27], s56 offen offset:1024 sc1
  s_waitcnt lgkmcnt(2)
  v_mfma_f32_32x32x16_bf16 v[112:127], v[68:71], v[180:183], v[112:127]
  ds_read_b64_tr_b16 v[60:61], v11 offset:28672
  ds_read_b64_tr_b16 v[62:63], v11 offset:29696
  buffer_load_dwordx4 v[36:39], v2, s[24:27], s57 offen offset:1024 sc1
  s_waitcnt vmcnt(9)
  s_waitcnt lgkmcnt(2)
  v_mfma_f32_32x32x16_bf16 v[96:111], v[56:59], v[184:187], v[96:111]
  ds_read_b64_tr_b16 v[64:65], v10 offset:30720
  ds_read_b64_tr_b16 v[66:67], v10 offset:31744
  buffer_load_dwordx4 v[216:219], v2, s[24:27], s56 offen offset:2048 sc1
  s_waitcnt lgkmcnt(2)
  v_mfma_f32_32x32x16_bf16 v[112:127], v[60:63], v[184:187], v[112:127]
  ds_read_b64_tr_b16 v[68:69], v11 offset:30720
  ds_read_b64_tr_b16 v[70:71], v11 offset:31744
  buffer_load_dwordx4 v[40:43], v2, s[24:27], s57 offen offset:2048 sc1
  s_waitcnt vmcnt(10)
  s_waitcnt lgkmcnt(2)
  v_mfma_f32_32x32x16_bf16 v[96:111], v[64:67], v[188:191], v[96:111]
  ds_read_b64_tr_b16 v[56:57], v10 offset:32768
  ds_read_b64_tr_b16 v[58:59], v10 offset:33792
  buffer_load_dwordx4 v[220:223], v2, s[24:27], s56 offen offset:3072 sc1
  s_add_u32 s56, s56, 4096
  s_waitcnt lgkmcnt(2)
  v_mfma_f32_32x32x16_bf16 v[112:127], v[68:71], v[188:191], v[112:127]
  ds_read_b64_tr_b16 v[60:61], v11 offset:32768
  ds_read_b64_tr_b16 v[62:63], v11 offset:33792
  buffer_load_dwordx4 v[44:47], v2, s[24:27], s57 offen offset:3072 sc1
  s_waitcnt vmcnt(11)
  s_waitcnt lgkmcnt(2)
  v_mfma_f32_32x32x16_bf16 v[96:111], v[56:59], v[192:195], v[96:111]
  ds_read_b64_tr_b16 v[64:65], v10 offset:34816
  ds_read_b64_tr_b16 v[66:67], v10 offset:35840
  buffer_load_dwordx4 v[224:227], v2, s[24:27], s56 offen offset:0 sc1
  s_waitcnt lgkmcnt(2)
  v_mfma_f32_32x32x16_bf16 v[112:127], v[60:63], v[192:195], v[112:127]
  ds_read_b64_tr_b16 v[68:69], v11 offset:34816
  ds_read_b64_tr_b16 v[70:71], v11 offset:35840
  s_waitcnt vmcnt(11)
  s_waitcnt lgkmcnt(2)
  v_mfma_f32_32x32x16_bf16 v[96:111], v[64:67], v[196:199], v[96:111]
  ds_read_b64_tr_b16 v[56:57], v10 offset:36864
  ds_read_b64_tr_b16 v[58:59], v10 offset:37888
  buffer_load_dwordx4 v[228:231], v2, s[24:27], s56 offen offset:1024 sc1
  s_waitcnt lgkmcnt(2)
  v_mfma_f32_32x32x16_bf16 v[112:127], v[68:71], v[196:199], v[112:127]
  ds_read_b64_tr_b16 v[60:61], v11 offset:36864
  ds_read_b64_tr_b16 v[62:63], v11 offset:37888
  s_waitcnt vmcnt(11)
  s_waitcnt lgkmcnt(2)
  v_mfma_f32_32x32x16_bf16 v[96:111], v[56:59], v[200:203], v[96:111]
  ds_read_b64_tr_b16 v[64:65], v10 offset:38912
  ds_read_b64_tr_b16 v[66:67], v10 offset:39936
  buffer_load_dwordx4 v[232:235], v2, s[24:27], s56 offen offset:2048 sc1
  s_waitcnt lgkmcnt(2)
  v_mfma_f32_32x32x16_bf16 v[112:127], v[60:63], v[200:203], v[112:127]
  ds_read_b64_tr_b16 v[68:69], v11 offset:38912
  ds_read_b64_tr_b16 v[70:71], v11 offset:39936
  s_waitcnt vmcnt(11)
  s_waitcnt lgkmcnt(2)
  v_mfma_f32_32x32x16_bf16 v[96:111], v[64:67], v[204:207], v[96:111]
  ds_read_b64_tr_b16 v[56:57], v10 offset:40960
  ds_read_b64_tr_b16 v[58:59], v10 offset:41984
  buffer_load_dwordx4 v[236:239], v2, s[24:27], s56 offen offset:3072 sc1
  s_add_u32 s56, s56, 4096
  s_waitcnt lgkmcnt(2)
  v_mfma_f32_32x32x16_bf16 v[112:127], v[68:71], v[204:207], v[112:127]
  ds_read_b64_tr_b16 v[60:61], v11 offset:40960
  ds_read_b64_tr_b16 v[62:63], v11 offset:41984
  s_waitcnt vmcnt(11)
  s_waitcnt lgkmcnt(2)
  v_mfma_f32_32x32x16_bf16 v[96:111], v[56:59], v[208:211], v[96:111]
  ds_read_b64_tr_b16 v[64:65], v10 offset:43008
  ds_read_b64_tr_b16 v[66:67], v10 offset:44032
  buffer_load_dwordx4 v[240:243], v2, s[24:27], s56 offen offset:0 sc1
  s_waitcnt lgkmcnt(2)
  v_mfma_f32_32x32x16_bf16 v[112:127], v[60:63], v[208:211], v[112:127]
  ds_read_b64_tr_b16 v[68:69], v11 offset:43008
  ds_read_b64_tr_b16 v[70:71], v11 offset:44032
  s_waitcnt vmcnt(10)
  s_waitcnt lgkmcnt(2)
  v_mfma_f32_32x32x16_bf16 v[96:111], v[64:67], v[212:215], v[96:111]
  ds_read_b64_tr_b16 v[56:57], v10 offset:45056
  ds_read_b64_tr_b16 v[58:59], v10 offset:46080
  buffer_load_dwordx4 v[244:247], v2, s[24:27], s56 offen offset:1024 sc1
  s_waitcnt lgkmcnt(2)
  v_mfma_f32_32x32x16_bf16 v[112:127], v[68:71], v[212:215], v[112:127]
  ds_read_b64_tr_b16 v[60:61], v11 offset:45056
  ds_read_b64_tr_b16 v[62:63], v11 offset:46080
  s_waitcnt vmcnt(9)
  s_waitcnt lgkmcnt(2)
  v_mfma_f32_32x32x16_bf16 v[96:111], v[56:59], v[216:219], v[96:111]
  ds_read_b64_tr_b16 v[64:65], v10 offset:47104
  ds_read_b64_tr_b16 v[66:67], v10 offset:48128
  buffer_load_dwordx4 v[248:251], v2, s[24:27], s56 offen offset:2048 sc1
  s_waitcnt lgkmcnt(2)
  v_mfma_f32_32x32x16_bf16 v[112:127], v[60:63], v[216:219], v[112:127]
  ds_read_b64_tr_b16 v[68:69], v11 offset:47104
  ds_read_b64_tr_b16 v[70:71], v11 offset:48128
  s_waitcnt vmcnt(8)
  s_waitcnt lgkmcnt(2)
  v_mfma_f32_32x32x16_bf16 v[96:111], v[64:67], v[220:223], v[96:111]
  ds_read_b64_tr_b16 v[56:57], v10 offset:49152
  ds_read_b64_tr_b16 v[58:59], v10 offset:50176
  buffer_load_dwordx4 v[252:255], v2, s[24:27], s56 offen offset:3072 sc1
  s_add_u32 s56, s56, 4096
  s_waitcnt lgkmcnt(2)
  v_mfma_f32_32x32x16_bf16 v[112:127], v[68:71], v[220:223], v[112:127]
  ds_read_b64_tr_b16 v[60:61], v11 offset:49152
  ds_read_b64_tr_b16 v[62:63], v11 offset:50176
  s_waitcnt vmcnt(7)
  s_waitcnt lgkmcnt(2)
  v_mfma_f32_32x32x16_bf16 v[96:111], v[56:59], v[224:227], v[96:111]
  ds_read_b64_tr_b16 v[64:65], v10 offset:51200
  ds_read_b64_tr_b16 v[66:67], v10 offset:52224
  s_waitcnt lgkmcnt(2)
  v_mfma_f32_32x32x16_bf16 v[112:127], v[60:63], v[224:227], v[112:127]
  ds_read_b64_tr_b16 v[68:69], v11 offset:51200
  ds_read_b64_tr_b16 v[70:71], v11 offset:52224
  v_pk_add_f32 v[32:33], v[32:33], v[40:41]
  v_pk_add_f32 v[34:35], v[34:35], v[42:43]
  v_pk_add_f32 v[36:37], v[36:37], v[44:45]
  v_pk_add_f32 v[38:39], v[38:39], v[46:47]
  s_waitcnt vmcnt(6)
  s_waitcnt lgkmcnt(2)
  v_mfma_f32_32x32x16_bf16 v[96:111], v[64:67], v[228:231], v[96:111]
  ds_read_b64_tr_b16 v[56:57], v10 offset:53248
  ds_read_b64_tr_b16 v[58:59], v10 offset:54272
  v_pk_add_f32 v[32:33], v[32:33], v[36:37]
  v_pk_add_f32 v[34:35], v[34:35], v[38:39]
  v_pk_add_f32 v[32:33], v[32:33], v[34:35]
  v_add_f32 v32, v32, v33
  s_waitcnt lgkmcnt(2)
  v_mfma_f32_32x32x16_bf16 v[112:127], v[68:71], v[228:231], v[112:127]
  ds_read_b64_tr_b16 v[60:61], v11 offset:53248
  ds_read_b64_tr_b16 v[62:63], v11 offset:54272
  v_mov_b32 v33, v32
  s_nop 1
  v_permlane32_swap_b32 v32, v33
  v_mul_f32 v32, 0x3b000000, v32
  v_mul_f32 v33, 0x3b000000, v33
  s_waitcnt vmcnt(5)
  s_waitcnt lgkmcnt(2)
  v_mfma_f32_32x32x16_bf16 v[96:111], v[56:59], v[232:235], v[96:111]
  ds_read_b64_tr_b16 v[64:65], v10 offset:55296
  ds_read_b64_tr_b16 v[66:67], v10 offset:56320
  v_fma_f32 v33, -v32, v32, v33
  v_max_f32 v33, 0, v33
  v_mov_b32 v36, v32
  v_cvt_pk_bf16_f32 v36, v36, v36
  s_waitcnt lgkmcnt(2)
  v_mfma_f32_32x32x16_bf16 v[112:127], v[60:63], v[232:235], v[112:127]
  ds_read_b64_tr_b16 v[68:69], v11 offset:55296
  ds_read_b64_tr_b16 v[70:71], v11 offset:56320
  v_lshlrev_b32 v36, 16, v36
  v_mov_b32 v34, v33
  v_cvt_pk_bf16_f32 v34, v34, v34
  v_lshlrev_b32 v34, 16, v34
  s_waitcnt vmcnt(4)
  s_waitcnt lgkmcnt(2)
  v_mfma_f32_32x32x16_bf16 v[96:111], v[64:67], v[236:239], v[96:111]
  ds_read_b64_tr_b16 v[56:57], v10 offset:57344
  ds_read_b64_tr_b16 v[58:59], v10 offset:58368
  v_add_f32 v34, 0x3727c5ac, v34
  v_cvt_pk_bf16_f32 v34, v34, v34
  v_lshlrev_b32 v34, 16, v34
  v_sqrt_f32 v34, v34
  s_waitcnt lgkmcnt(2)
  v_mfma_f32_32x32x16_bf16 v[112:127], v[68:71], v[236:239], v[112:127]
  ds_read_b64_tr_b16 v[60:61], v11 offset:57344
  ds_read_b64_tr_b16 v[62:63], v11 offset:58368
  v_cvt_pk_bf16_f32 v34, v34, v34
  v_lshlrev_b32 v34, 16, v34
  v_rcp_f32 v37, v34
  v_sub_f32 v32, v32, v36
  s_waitcnt vmcnt(3)
  s_waitcnt lgkmcnt(2)
  v_mfma_f32_32x32x16_bf16 v[96:111], v[56:59], v[240:243], v[96:111]
  ds_read_b64_tr_b16 v[64:65], v10 offset:59392
  ds_read_b64_tr_b16 v[66:67], v10 offset:60416
  v_mul_f32 v32, v32, v37
  v_cvt_pk_bf16_f32 v32, v32, v32
  v_lshlrev_b32 v32, 16, v32
  v_fmac_f32 v36, v32, v34
  s_waitcnt lgkmcnt(2)
  v_mfma_f32_32x32x16_bf16 v[112:127], v[60:63], v[240:243], v[112:127]
  ds_read_b64_tr_b16 v[68:69], v11 offset:59392
  ds_read_b64_tr_b16 v[70:71], v11 offset:60416
  v_mul_f32 v35, v37, v37
  v_mul_f32 v35, v35, v33
  v_cvt_pk_bf16_f32 v35, v35, v35
  v_lshlrev_b32 v35, 16, v35
  s_waitcnt vmcnt(2)
  s_waitcnt lgkmcnt(2)
  v_mfma_f32_32x32x16_bf16 v[96:111], v[64:67], v[244:247], v[96:111]
  ds_read_b64_tr_b16 v[56:57], v10 offset:61440
  ds_read_b64_tr_b16 v[58:59], v10 offset:62464
  v_add_f32 v35, 0x3727c5ac, v35
  v_cvt_pk_bf16_f32 v35, v35, v35
  v_lshlrev_b32 v35, 16, v35
  v_sqrt_f32 v35, v35
  s_waitcnt lgkmcnt(2)
  v_mfma_f32_32x32x16_bf16 v[112:127], v[68:71], v[244:247], v[112:127]
  ds_read_b64_tr_b16 v[60:61], v11 offset:61440
  ds_read_b64_tr_b16 v[62:63], v11 offset:62464
  v_cvt_pk_bf16_f32 v35, v35, v35
  v_lshlrev_b32 v35, 16, v35
  v_rcp_f32 v35, v35
  s_nop 0
  v_mul_f32 v37, v37, v35
  s_waitcnt vmcnt(1)
  s_waitcnt lgkmcnt(2)
  v_mfma_f32_32x32x16_bf16 v[96:111], v[56:59], v[248:251], v[96:111]
  ds_read_b64_tr_b16 v[64:65], v10 offset:63488
  ds_read_b64_tr_b16 v[66:67], v10 offset:64512
  v_mul_f32 v8, 0xbeeff558, v37
  v_mov_b32 v32, v36
  v_mul_f32 v9, v32, v8
  v_sub_f32 v9, 0, v9
  s_waitcnt lgkmcnt(2)
  v_mfma_f32_32x32x16_bf16 v[112:127], v[60:63], v[248:251], v[112:127]
  ds_read_b64_tr_b16 v[68:69], v11 offset:63488
  ds_read_b64_tr_b16 v[70:71], v11 offset:64512
  s_waitcnt vmcnt(0)
  s_waitcnt lgkmcnt(2)
  v_mfma_f32_32x32x16_bf16 v[96:111], v[64:67], v[252:255], v[96:111]
  s_waitcnt lgkmcnt(0)
  v_mfma_f32_32x32x16_bf16 v[112:127], v[68:71], v[252:255], v[112:127]
  s_barrier
  ds_read_b64_tr_b16 v[56:57], v4 offset:0
  ds_read_b64_tr_b16 v[58:59], v4 offset:512
  ds_read_b64_tr_b16 v[60:61], v4 offset:1024
  ds_read_b64_tr_b16 v[62:63], v4 offset:1536
  ds_read_b64_tr_b16 v[64:65], v4 offset:2048
  ds_read_b64_tr_b16 v[66:67], v4 offset:2560
  s_waitcnt lgkmcnt(4)
  v_mfma_f32_32x32x16_bf16 v[80:95], v[56:59], v[128:131], 0
  ds_read_b64_tr_b16 v[68:69], v4 offset:3072
  ds_read_b64_tr_b16 v[70:71], v4 offset:3584
  s_waitcnt lgkmcnt(4)
  v_mfma_f32_32x32x16_bf16 v[80:95], v[60:63], v[132:135], v[80:95]
  ds_read_b64_tr_b16 v[56:57], v4 offset:4096
  ds_read_b64_tr_b16 v[58:59], v4 offset:4608
  s_waitcnt lgkmcnt(4)
  v_mfma_f32_32x32x16_bf16 v[80:95], v[64:67], v[136:139], v[80:95]
  ds_read_b64_tr_b16 v[60:61], v4 offset:5120
  ds_read_b64_tr_b16 v[62:63], v4 offset:5632
  s_waitcnt lgkmcnt(4)
  v_mfma_f32_32x32x16_bf16 v[80:95], v[68:71], v[140:143], v[80:95]
  ds_read_b64_tr_b16 v[64:65], v4 offset:6144
  ds_read_b64_tr_b16 v[66:67], v4 offset:6656
  s_waitcnt lgkmcnt(4)
  v_mfma_f32_32x32x16_bf16 v[80:95], v[56:59], v[144:147], v[80:95]
  ds_read_b64_tr_b16 v[68:69], v4 offset:7168
  ds_read_b64_tr_b16 v[70:71], v4 offset:7680
  s_waitcnt lgkmcnt(4)
  v_mfma_f32_32x32x16_bf16 v[80:95], v[60:63], v[148:151], v[80:95]
  ds_read_b64_tr_b16 v[56:57], v4 offset:8192
  ds_read_b64_tr_b16 v[58:59], v4 offset:8704
  s_waitcnt lgkmcnt(4)
  v_mfma_f32_32x32x16_bf16 v[80:95], v[64:67], v[152:155], v[80:95]
  ds_read_b64_tr_b16 v[60:61], v4 offset:9216
  ds_read_b64_tr_b16 v[62:63], v4 offset:9728
  s_waitcnt lgkmcnt(4)
  v_mfma_f32_32x32x16_bf16 v[80:95], v[68:71], v[156:159], v[80:95]
  ds_read_b64_tr_b16 v[64:65], v4 offset:10240
  ds_read_b64_tr_b16 v[66:67], v4 offset:10752
  s_waitcnt lgkmcnt(4)
  v_mfma_f32_32x32x16_bf16 v[80:95], v[56:59], v[160:163], v[80:95]
  ds_read_b64_tr_b16 v[68:69], v4 offset:11264
  ds_read_b64_tr_b16 v[70:71], v4 offset:11776
  s_waitcnt lgkmcnt(4)
  v_mfma_f32_32x32x16_bf16 v[80:95], v[60:63], v[164:167], v[80:95]
  ds_read_b64_tr_b16 v[56:57], v4 offset:12288
  ds_read_b64_tr_b16 v[58:59], v4 offset:12800
  s_waitcnt lgkmcnt(4)
  v_mfma_f32_32x32x16_bf16 v[80:95], v[64:67], v[168:171], v[80:95]
  ds_read_b64_tr_b16 v[60:61], v4 offset:13312
  ds_read_b64_tr_b16 v[62:63], v4 offset:13824
  s_waitcnt lgkmcnt(4)
  v_mfma_f32_32x32x16_bf16 v[80:95], v[68:71], v[172:175], v[80:95]
  ds_read_b64_tr_b16 v[64:65], v4 offset:14336
  ds_read_b64_tr_b16 v[66:67], v4 offset:14848
  s_waitcnt lgkmcnt(4)
  v_mfma_f32_32x32x16_bf16 v[80:95], v[56:59], v[176:179], v[80:95]
  ds_read_b64_tr_b16 v[68:69], v4 offset:15360
  ds_read_b64_tr_b16 v[70:71], v4 offset:15872
  s_waitcnt lgkmcnt(4)
  v_mfma_f32_32x32x16_bf16 v[80:95], v[60:63], v[180:183], v[80:95]
  ds_read_b64_tr_b16 v[56:57], v4 offset:16384
  ds_read_b64_tr_b16 v[58:59], v4 offset:16896
  s_waitcnt lgkmcnt(4)
  v_mfma_f32_32x32x16_bf16 v[80:95], v[64:67], v[184:187], v[80:95]
  ds_read_b64_tr_b16 v[60:61], v4 offset:17408
  ds_read_b64_tr_b16 v[62:63], v4 offset:17920
  s_waitcnt lgkmcnt(4)
  v_mfma_f32_32x32x16_bf16 v[80:95], v[68:71], v[188:191], v[80:95]
  ds_read_b64_tr_b16 v[64:65], v4 offset:18432
  ds_read_b64_tr_b16 v[66:67], v4 offset:18944
  s_waitcnt lgkmcnt(4)
  v_mfma_f32_32x32x16_bf16 v[80:95], v[56:59], v[192:195], v[80:95]
  ds_read_b64_tr_b16 v[68:69], v4 offset:19456
  ds_read_b64_tr_b16 v[70:71], v4 offset:19968
  s_waitcnt lgkmcnt(4)
  v_mfma_f32_32x32x16_bf16 v[80:95], v[60:63], v[196:199], v[80:95]
  ds_read_b64_tr_b16 v[56:57], v4 offset:20480
  ds_read_b64_tr_b16 v[58:59], v4 offset:20992
  s_waitcnt lgkmcnt(4)
  v_mfma_f32_32x32x16_bf16 v[80:95], v[64:67], v[200:203], v[80:95]
  ds_read_b64_tr_b16 v[60:61], v4 offset:21504
  ds_read_b64_tr_b16 v[62:63], v4 offset:22016
  s_waitcnt lgkmcnt(4)
  v_mfma_f32_32x32x16_bf16 v[80:95], v[68:71], v[204:207], v[80:95]
  ds_read_b64_tr_b16 v[64:65], v4 offset:22528
  ds_read_b64_tr_b16 v[66:67], v4 offset:23040
  s_waitcnt lgkmcnt(4)
  v_mfma_f32_32x32x16_bf16 v[80:95], v[56:59], v[208:211], v[80:95]
  ds_read_b64_tr_b16 v[68:69], v4 offset:23552
  ds_read_b64_tr_b16 v[70:71], v4 offset:24064
  s_waitcnt lgkmcnt(4)
  v_mfma_f32_32x32x16_bf16 v[80:95], v[60:63], v[212:215], v[80:95]
  ds_read_b64_tr_b16 v[56:57], v4 offset:24576
  ds_read_b64_tr_b16 v[58:59], v4 offset:25088
  s_waitcnt lgkmcnt(4)
  v_mfma_f32_32x32x16_bf16 v[80:95], v[64:67], v[216:219], v[80:95]
  ds_read_b64_tr_b16 v[60:61], v4 offset:25600
  ds_read_b64_tr_b16 v[62:63], v4 offset:26112
  s_waitcnt lgkmcnt(4)
  v_mfma_f32_32x32x16_bf16 v[80:95], v[68:71], v[220:223], v[80:95]
  ds_read_b64_tr_b16 v[64:65], v4 offset:26624
  ds_read_b64_tr_b16 v[66:67], v4 offset:27136
  s_waitcnt lgkmcnt(4)
  v_mfma_f32_32x32x16_bf16 v[80:95], v[56:59], v[224:227], v[80:95]
  ds_read_b64_tr_b16 v[68:69], v4 offset:27648
  ds_read_b64_tr_b16 v[70:71], v4 offset:28160
  s_waitcnt lgkmcnt(4)
  v_mfma_f32_32x32x16_bf16 v[80:95], v[60:63], v[228:231], v[80:95]
  ds_read_b64_tr_b16 v[56:57], v4 offset:28672
  ds_read_b64_tr_b16 v[58:59], v4 offset:29184
  s_waitcnt lgkmcnt(4)
  v_mfma_f32_32x32x16_bf16 v[80:95], v[64:67], v[232:235], v[80:95]
  ds_read_b64_tr_b16 v[60:61], v4 offset:29696
  ds_read_b64_tr_b16 v[62:63], v4 offset:30208
  s_waitcnt lgkmcnt(4)
  v_mfma_f32_32x32x16_bf16 v[80:95], v[68:71], v[236:239], v[80:95]
  ds_read_b64_tr_b16 v[64:65], v4 offset:30720
  ds_read_b64_tr_b16 v[66:67], v4 offset:31232
  s_waitcnt lgkmcnt(4)
  v_mfma_f32_32x32x16_bf16 v[80:95], v[56:59], v[240:243], v[80:95]
  ds_read_b64_tr_b16 v[68:69], v4 offset:31744
  ds_read_b64_tr_b16 v[70:71], v4 offset:32256
  s_waitcnt lgkmcnt(4)
  v_mfma_f32_32x32x16_bf16 v[80:95], v[60:63], v[244:247], v[80:95]
  s_waitcnt lgkmcnt(2)
  v_mfma_f32_32x32x16_bf16 v[80:95], v[64:67], v[248:251], v[80:95]
  s_waitcnt lgkmcnt(0)
  v_mfma_f32_32x32x16_bf16 v[80:95], v[68:71], v[252:255], v[80:95]
  ds_read_b128 v[16:19], v13 offset:128
  ds_read_b128 v[20:23], v13 offset:160
  ds_read_b128 v[24:27], v13 offset:192
  ds_read_b128 v[28:31], v13 offset:224
  ds_read_b128 v[32:35], v13 offset:512
  ds_read_b128 v[36:39], v13 offset:544
  ds_read_b128 v[40:43], v13 offset:576
  ds_read_b128 v[44:47], v13 offset:608
  ds_read_b128 v[128:131], v13 offset:256
  ds_read_b128 v[132:135], v13 offset:288
  ds_read_b128 v[136:139], v13 offset:320
  ds_read_b128 v[140:143], v13 offset:352
  ds_read_b128 v[144:147], v13 offset:640
  ds_read_b128 v[148:151], v13 offset:672
  ds_read_b128 v[152:155], v13 offset:704
  ds_read_b128 v[156:159], v13 offset:736
  s_barrier
  s_waitcnt lgkmcnt(8)
  v_pk_fma_f32 v[32:33], v[16:17], v[8:9], v[32:33] op_sel:[0,1,0] op_sel_hi:[1,1,1]
  v_pk_fma_f32 v[34:35], v[18:19], v[8:9], v[34:35] op_sel:[0,1,0] op_sel_hi:[1,1,1]
  v_pk_fma_f32 v[36:37], v[20:21], v[8:9], v[36:37] op_sel:[0,1,0] op_sel_hi:[1,1,1]
  v_pk_fma_f32 v[38:39], v[22:23], v[8:9], v[38:39] op_sel:[0,1,0] op_sel_hi:[1,1,1]
  v_pk_fma_f32 v[40:41], v[24:25], v[8:9], v[40:41] op_sel:[0,1,0] op_sel_hi:[1,1,1]
  v_pk_fma_f32 v[42:43], v[26:27], v[8:9], v[42:43] op_sel:[0,1,0] op_sel_hi:[1,1,1]
  v_pk_fma_f32 v[44:45], v[28:29], v[8:9], v[44:45] op_sel:[0,1,0] op_sel_hi:[1,1,1]
  v_pk_fma_f32 v[46:47], v[30:31], v[8:9], v[46:47] op_sel:[0,1,0] op_sel_hi:[1,1,1]
  v_pk_fma_f32 v[32:33], v[96:97], v[8:9], v[32:33] op_sel_hi:[1,0,1]
  v_pk_fma_f32 v[34:35], v[98:99], v[8:9], v[34:35] op_sel_hi:[1,0,1]
  v_pk_fma_f32 v[36:37], v[100:101], v[8:9], v[36:37] op_sel_hi:[1,0,1]
  v_pk_fma_f32 v[38:39], v[102:103], v[8:9], v[38:39] op_sel_hi:[1,0,1]
  v_pk_fma_f32 v[40:41], v[104:105], v[8:9], v[40:41] op_sel_hi:[1,0,1]
  v_pk_fma_f32 v[42:43], v[106:107], v[8:9], v[42:43] op_sel_hi:[1,0,1]
  v_pk_fma_f32 v[44:45], v[108:109], v[8:9], v[44:45] op_sel_hi:[1,0,1]
  v_pk_fma_f32 v[46:47], v[110:111], v[8:9], v[46:47] op_sel_hi:[1,0,1]
  v_pk_fma_f32 v[16:17], v[32:33], v[32:33], s[100:101]
  v_pk_fma_f32 v[18:19], v[34:35], v[34:35], s[100:101]
  v_pk_fma_f32 v[20:21], v[36:37], v[36:37], s[100:101]
  v_pk_fma_f32 v[22:23], v[38:39], v[38:39], s[100:101]
  v_pk_fma_f32 v[24:25], v[40:41], v[40:41], s[100:101]
  v_pk_fma_f32 v[26:27], v[42:43], v[42:43], s[100:101]
  v_pk_fma_f32 v[28:29], v[44:45], v[44:45], s[100:101]
  v_pk_fma_f32 v[30:31], v[46:47], v[46:47], s[100:101]
  v_pk_mul_f32 v[16:17], v[32:33], v[16:17]
  v_pk_mul_f32 v[18:19], v[34:35], v[18:19]
  v_pk_mul_f32 v[20:21], v[36:37], v[20:21]
  v_pk_mul_f32 v[22:23], v[38:39], v[22:23]
  v_pk_mul_f32 v[24:25], v[40:41], v[24:25]
  v_pk_mul_f32 v[26:27], v[42:43], v[26:27]
  v_pk_mul_f32 v[28:29], v[44:45], v[28:29]
  v_pk_mul_f32 v[30:31], v[46:47], v[30:31]
  v_exp_f32 v16, v16
  v_exp_f32 v17, v17
  v_exp_f32 v18, v18
  v_exp_f32 v19, v19
  v_exp_f32 v20, v20
  v_exp_f32 v21, v21
  v_exp_f32 v22, v22
  v_exp_f32 v23, v23
  v_exp_f32 v24, v24
  v_exp_f32 v25, v25
  v_exp_f32 v26, v26
  v_exp_f32 v27, v27
  v_exp_f32 v28, v28
  v_exp_f32 v29, v29
  v_exp_f32 v30, v30
  v_exp_f32 v31, v31
  v_pk_add_f32 v[16:17], v[16:17], s[4:5]
  v_pk_add_f32 v[18:19], v[18:19], s[4:5]
  v_pk_add_f32 v[20:21], v[20:21], s[4:5]
  v_pk_add_f32 v[22:23], v[22:23], s[4:5]
  v_pk_add_f32 v[24:25], v[24:25], s[4:5]
  v_pk_add_f32 v[26:27], v[26:27], s[4:5]
  v_pk_add_f32 v[28:29], v[28:29], s[4:5]
  v_pk_add_f32 v[30:31], v[30:31], s[4:5]
  v_rcp_f32 v16, v16
  v_rcp_f32 v17, v17
  v_rcp_f32 v18, v18
  v_rcp_f32 v19, v19
  v_rcp_f32 v20, v20
  v_rcp_f32 v21, v21
  v_rcp_f32 v22, v22
  v_rcp_f32 v23, v23
  v_rcp_f32 v24, v24
  v_rcp_f32 v25, v25
  v_rcp_f32 v26, v26
  v_rcp_f32 v27, v27
  v_rcp_f32 v28, v28
  v_rcp_f32 v29, v29
  v_rcp_f32 v30, v30
  v_rcp_f32 v31, v31
  v_pk_mul_f32 v[32:33], v[32:33], v[16:17]
  v_pk_mul_f32 v[34:35], v[34:35], v[18:19]
  v_pk_mul_f32 v[36:37], v[36:37], v[20:21]
  v_pk_mul_f32 v[38:39], v[38:39], v[22:23]
  v_pk_mul_f32 v[40:41], v[40:41], v[24:25]
  v_pk_mul_f32 v[42:43], v[42:43], v[26:27]
  v_pk_mul_f32 v[44:45], v[44:45], v[28:29]
  v_pk_mul_f32 v[46:47], v[46:47], v[30:31]
  v_cvt_pk_bf16_f32 v48, v32, v33
  v_cvt_pk_bf16_f32 v49, v34, v35
  v_cvt_pk_bf16_f32 v50, v36, v37
  v_cvt_pk_bf16_f32 v51, v38, v39
  v_cvt_pk_bf16_f32 v52, v40, v41
  v_cvt_pk_bf16_f32 v53, v42, v43
  v_cvt_pk_bf16_f32 v54, v44, v45
  v_cvt_pk_bf16_f32 v55, v46, v47
  s_waitcnt lgkmcnt(0)
  v_pk_fma_f32 v[144:145], v[128:129], v[8:9], v[144:145] op_sel:[0,1,0] op_sel_hi:[1,1,1]
  v_pk_fma_f32 v[146:147], v[130:131], v[8:9], v[146:147] op_sel:[0,1,0] op_sel_hi:[1,1,1]
  v_pk_fma_f32 v[148:149], v[132:133], v[8:9], v[148:149] op_sel:[0,1,0] op_sel_hi:[1,1,1]
  v_pk_fma_f32 v[150:151], v[134:135], v[8:9], v[150:151] op_sel:[0,1,0] op_sel_hi:[1,1,1]
  v_pk_fma_f32 v[152:153], v[136:137], v[8:9], v[152:153] op_sel:[0,1,0] op_sel_hi:[1,1,1]
  v_pk_fma_f32 v[154:155], v[138:139], v[8:9], v[154:155] op_sel:[0,1,0] op_sel_hi:[1,1,1]
  v_pk_fma_f32 v[156:157], v[140:141], v[8:9], v[156:157] op_sel:[0,1,0] op_sel_hi:[1,1,1]
  v_pk_fma_f32 v[158:159], v[142:143], v[8:9], v[158:159] op_sel:[0,1,0] op_sel_hi:[1,1,1]
  v_pk_fma_f32 v[144:145], v[112:113], v[8:9], v[144:145] op_sel_hi:[1,0,1]
  v_pk_fma_f32 v[146:147], v[114:115], v[8:9], v[146:147] op_sel_hi:[1,0,1]
  v_pk_fma_f32 v[148:149], v[116:117], v[8:9], v[148:149] op_sel_hi:[1,0,1]
  v_pk_fma_f32 v[150:151], v[118:119], v[8:9], v[150:151] op_sel_hi:[1,0,1]
  v_pk_fma_f32 v[152:153], v[120:121], v[8:9], v[152:153] op_sel_hi:[1,0,1]
  v_pk_fma_f32 v[154:155], v[122:123], v[8:9], v[154:155] op_sel_hi:[1,0,1]
  v_pk_fma_f32 v[156:157], v[124:125], v[8:9], v[156:157] op_sel_hi:[1,0,1]
  v_pk_fma_f32 v[158:159], v[126:127], v[8:9], v[158:159] op_sel_hi:[1,0,1]
  v_pk_fma_f32 v[128:129], v[144:145], v[144:145], s[100:101]
  v_pk_fma_f32 v[130:131], v[146:147], v[146:147], s[100:101]
  v_pk_fma_f32 v[132:133], v[148:149], v[148:149], s[100:101]
  v_pk_fma_f32 v[134:135], v[150:151], v[150:151], s[100:101]
  v_pk_fma_f32 v[136:137], v[152:153], v[152:153], s[100:101]
  v_pk_fma_f32 v[138:139], v[154:155], v[154:155], s[100:101]
  v_pk_fma_f32 v[140:141], v[156:157], v[156:157], s[100:101]
  v_pk_fma_f32 v[142:143], v[158:159], v[158:159], s[100:101]
  v_pk_mul_f32 v[128:129], v[144:145], v[128:129]
  v_pk_mul_f32 v[130:131], v[146:147], v[130:131]
  v_pk_mul_f32 v[132:133], v[148:149], v[132:133]
  v_pk_mul_f32 v[134:135], v[150:151], v[134:135]
  v_pk_mul_f32 v[136:137], v[152:153], v[136:137]
  v_pk_mul_f32 v[138:139], v[154:155], v[138:139]
  v_pk_mul_f32 v[140:141], v[156:157], v[140:141]
  v_pk_mul_f32 v[142:143], v[158:159], v[142:143]
  v_exp_f32 v128, v128
  v_exp_f32 v129, v129
  v_exp_f32 v130, v130
  v_exp_f32 v131, v131
  v_exp_f32 v132, v132
  v_exp_f32 v133, v133
  v_exp_f32 v134, v134
  v_exp_f32 v135, v135
  v_exp_f32 v136, v136
  v_exp_f32 v137, v137
  v_exp_f32 v138, v138
  v_exp_f32 v139, v139
  v_exp_f32 v140, v140
  v_exp_f32 v141, v141
  v_exp_f32 v142, v142
  v_exp_f32 v143, v143
  v_pk_add_f32 v[128:129], v[128:129], s[4:5]
  v_pk_add_f32 v[130:131], v[130:131], s[4:5]
  v_pk_add_f32 v[132:133], v[132:133], s[4:5]
  v_pk_add_f32 v[134:135], v[134:135], s[4:5]
  v_pk_add_f32 v[136:137], v[136:137], s[4:5]
  v_pk_add_f32 v[138:139], v[138:139], s[4:5]
  v_pk_add_f32 v[140:141], v[140:141], s[4:5]
  v_pk_add_f32 v[142:143], v[142:143], s[4:5]
  v_rcp_f32 v128, v128
  v_rcp_f32 v129, v129
  v_rcp_f32 v130, v130
  v_rcp_f32 v131, v131
  v_rcp_f32 v132, v132
  v_rcp_f32 v133, v133
  v_rcp_f32 v134, v134
  v_rcp_f32 v135, v135
  v_rcp_f32 v136, v136
  v_rcp_f32 v137, v137
  v_rcp_f32 v138, v138
  v_rcp_f32 v139, v139
  v_rcp_f32 v140, v140
  v_rcp_f32 v141, v141
  v_rcp_f32 v142, v142
  v_rcp_f32 v143, v143
  v_pk_mul_f32 v[144:145], v[144:145], v[128:129]
  v_pk_mul_f32 v[146:147], v[146:147], v[130:131]
  v_pk_mul_f32 v[148:149], v[148:149], v[132:133]
  v_pk_mul_f32 v[150:151], v[150:151], v[134:135]
  v_pk_mul_f32 v[152:153], v[152:153], v[136:137]
  v_pk_mul_f32 v[154:155], v[154:155], v[138:139]
  v_pk_mul_f32 v[156:157], v[156:157], v[140:141]
  v_pk_mul_f32 v[158:159], v[158:159], v[142:143]
  v_cvt_pk_bf16_f32 v56, v144, v145
  v_cvt_pk_bf16_f32 v57, v146, v147
  v_cvt_pk_bf16_f32 v58, v148, v149
  v_cvt_pk_bf16_f32 v59, v150, v151
  v_cvt_pk_bf16_f32 v60, v152, v153
  v_cvt_pk_bf16_f32 v61, v154, v155
  v_cvt_pk_bf16_f32 v62, v156, v157
  v_cvt_pk_bf16_f32 v63, v158, v159
  s_cmp_ge_u32 s52, 11
  s_cbranch_scc1 Lt2_82
  ds_read_b128 v[16:19], v13 offset:0
  ds_read_b128 v[20:23], v13 offset:32
  ds_read_b128 v[24:27], v13 offset:64
  ds_read_b128 v[28:31], v13 offset:96
  ds_read_b128 v[32:35], v13 offset:384
  ds_read_b128 v[36:39], v13 offset:416
  ds_read_b128 v[40:43], v13 offset:448
  ds_read_b128 v[44:47], v13 offset:480
  s_waitcnt lgkmcnt(0)
  v_pk_fma_f32 v[32:33], v[16:17], v[8:9], v[32:33] op_sel:[0,1,0] op_sel_hi:[1,1,1]
  v_pk_fma_f32 v[34:35], v[18:19], v[8:9], v[34:35] op_sel:[0,1,0] op_sel_hi:[1,1,1]
  v_pk_fma_f32 v[36:37], v[20:21], v[8:9], v[36:37] op_sel:[0,1,0] op_sel_hi:[1,1,1]
  v_pk_fma_f32 v[38:39], v[22:23], v[8:9], v[38:39] op_sel:[0,1,0] op_sel_hi:[1,1,1]
  v_pk_fma_f32 v[40:41], v[24:25], v[8:9], v[40:41] op_sel:[0,1,0] op_sel_hi:[1,1,1]
  v_pk_fma_f32 v[42:43], v[26:27], v[8:9], v[42:43] op_sel:[0,1,0] op_sel_hi:[1,1,1]
  v_pk_fma_f32 v[44:45], v[28:29], v[8:9], v[44:45] op_sel:[0,1,0] op_sel_hi:[1,1,1]
  v_pk_fma_f32 v[46:47], v[30:31], v[8:9], v[46:47] op_sel:[0,1,0] op_sel_hi:[1,1,1]
  v_pk_fma_f32 v[32:33], v[80:81], v[8:9], v[32:33] op_sel_hi:[1,0,1]
  v_pk_fma_f32 v[34:35], v[82:83], v[8:9], v[34:35] op_sel_hi:[1,0,1]
  v_pk_fma_f32 v[36:37], v[84:85], v[8:9], v[36:37] op_sel_hi:[1,0,1]
  v_pk_fma_f32 v[38:39], v[86:87], v[8:9], v[38:39] op_sel_hi:[1,0,1]
  v_pk_fma_f32 v[40:41], v[88:89], v[8:9], v[40:41] op_sel_hi:[1,0,1]
  v_pk_fma_f32 v[42:43], v[90:91], v[8:9], v[42:43] op_sel_hi:[1,0,1]
  v_pk_fma_f32 v[44:45], v[92:93], v[8:9], v[44:45] op_sel_hi:[1,0,1]
  v_pk_fma_f32 v[46:47], v[94:95], v[8:9], v[46:47] op_sel_hi:[1,0,1]
  v_pk_fma_f32 v[16:17], v[32:33], v[32:33], s[100:101]
  v_pk_fma_f32 v[18:19], v[34:35], v[34:35], s[100:101]
  v_pk_fma_f32 v[20:21], v[36:37], v[36:37], s[100:101]
  v_pk_fma_f32 v[22:23], v[38:39], v[38:39], s[100:101]
  v_pk_fma_f32 v[24:25], v[40:41], v[40:41], s[100:101]
  v_pk_fma_f32 v[26:27], v[42:43], v[42:43], s[100:101]
  v_pk_fma_f32 v[28:29], v[44:45], v[44:45], s[100:101]
  v_pk_fma_f32 v[30:31], v[46:47], v[46:47], s[100:101]
  v_pk_mul_f32 v[16:17], v[32:33], v[16:17]
  v_pk_mul_f32 v[18:19], v[34:35], v[18:19]
  v_pk_mul_f32 v[20:21], v[36:37], v[20:21]
  v_pk_mul_f32 v[22:23], v[38:39], v[22:23]
  v_pk_mul_f32 v[24:25], v[40:41], v[24:25]
  v_pk_mul_f32 v[26:27], v[42:43], v[26:27]
  v_pk_mul_f32 v[28:29], v[44:45], v[28:29]
  v_pk_mul_f32 v[30:31], v[46:47], v[30:31]
  v_exp_f32 v16, v16
  v_exp_f32 v17, v17
  v_exp_f32 v18, v18
  v_exp_f32 v19, v19
  v_exp_f32 v20, v20
  v_exp_f32 v21, v21
  v_exp_f32 v22, v22
  v_exp_f32 v23, v23
  v_exp_f32 v24, v24
  v_exp_f32 v25, v25
  v_exp_f32 v26, v26
  v_exp_f32 v27, v27
  v_exp_f32 v28, v28
  v_exp_f32 v29, v29
  v_exp_f32 v30, v30
  v_exp_f32 v31, v31
  v_pk_add_f32 v[16:17], v[16:17], s[4:5]
  v_pk_add_f32 v[18:19], v[18:19], s[4:5]
  v_pk_add_f32 v[20:21], v[20:21], s[4:5]
  v_pk_add_f32 v[22:23], v[22:23], s[4:5]
  v_pk_add_f32 v[24:25], v[24:25], s[4:5]
  v_pk_add_f32 v[26:27], v[26:27], s[4:5]
  v_pk_add_f32 v[28:29], v[28:29], s[4:5]
  v_pk_add_f32 v[30:31], v[30:31], s[4:5]
  v_rcp_f32 v16, v16
  v_rcp_f32 v17, v17
  v_rcp_f32 v18, v18
  v_rcp_f32 v19, v19
  v_rcp_f32 v20, v20
  v_rcp_f32 v21, v21
  v_rcp_f32 v22, v22
  v_rcp_f32 v23, v23
  v_rcp_f32 v24, v24
  v_rcp_f32 v25, v25
  v_rcp_f32 v26, v26
  v_rcp_f32 v27, v27
  v_rcp_f32 v28, v28
  v_rcp_f32 v29, v29
  v_rcp_f32 v30, v30
  v_rcp_f32 v31, v31
  v_pk_mul_f32 v[32:33], v[32:33], v[16:17]
  v_pk_mul_f32 v[34:35], v[34:35], v[18:19]
  v_pk_mul_f32 v[36:37], v[36:37], v[20:21]
  v_pk_mul_f32 v[38:39], v[38:39], v[22:23]
  v_pk_mul_f32 v[40:41], v[40:41], v[24:25]
  v_pk_mul_f32 v[42:43], v[42:43], v[26:27]
  v_pk_mul_f32 v[44:45], v[44:45], v[28:29]
  v_pk_mul_f32 v[46:47], v[46:47], v[30:31]
  v_cvt_pk_bf16_f32 v64, v32, v33
  v_cvt_pk_bf16_f32 v65, v34, v35
  v_cvt_pk_bf16_f32 v66, v36, v37
  v_cvt_pk_bf16_f32 v67, v38, v39
  v_cvt_pk_bf16_f32 v68, v40, v41
  v_cvt_pk_bf16_f32 v69, v42, v43
  v_cvt_pk_bf16_f32 v70, v44, v45
  v_cvt_pk_bf16_f32 v71, v46, v47
  s_add_u32 s59, s58, 4096
  s_cmp_eq_u32 s45, 0
  s_cbranch_scc1 Lgs_84
  buffer_store_dwordx4 v[64:67], v2, s[24:27], s59 offen
  buffer_store_dwordx4 v[68:71], v2, s[24:27], s59 offen offset:1024
  s_branch Lgsd_85
Lgs_84:
  buffer_store_dwordx4 v[64:67], v2, s[24:27], s59 offen sc1
  buffer_store_dwordx4 v[68:71], v2, s[24:27], s59 offen offset:1024 sc1
Lgsd_85:
Lt2_82:
  s_cmp_eq_u32 s45, 0
  s_cbranch_scc1 Lgs_86
  buffer_store_dwordx4 v[48:51], v2, s[24:27], s58 offen offset:0
  buffer_store_dwordx4 v[52:55], v2, s[24:27], s58 offen offset:1024
  buffer_store_dwordx4 v[56:59], v2, s[24:27], s58 offen offset:2048
  buffer_store_dwordx4 v[60:63], v2, s[24:27], s58 offen offset:3072
  s_branch Lgsd_87
Lgs_86:
  buffer_store_dwordx4 v[48:51], v2, s[24:27], s58 offen offset:0 sc1
  buffer_store_dwordx4 v[52:55], v2, s[24:27], s58 offen offset:1024 sc1
  buffer_store_dwordx4 v[56:59], v2, s[24:27], s58 offen offset:2048 sc1
  buffer_store_dwordx4 v[60:63], v2, s[24:27], s58 offen offset:3072 sc1
Lgsd_87:
  s_waitcnt vmcnt(0)
  s_mov_b64 exec, 1
  v_mov_b32 v14, s43
  v_mov_b32 v15, 0
  s_cmp_eq_u32 s45, 0
  s_cbranch_scc1 Lgs_88
  buffer_store_dword v14, v15, s[24:27], s64 offen
  s_branch Lgsd_89
Lgs_88:
  buffer_store_dword v14, v15, s[24:27], s64 offen sc1
Lgsd_89:
  s_mov_b64 exec, -1
  s_barrier
  s_branch L_mlp1_d
L_mlp1_h:
  s_waitcnt vmcnt(0)
  s_barrier
  s_cmp_eq_u32 s42, 4
  s_cbranch_scc1 Lm4_90
  s_waitcnt lgkmcnt(0)
  s_cmp_lg_u32 s47, 0
  s_cbranch_scc1 Lcsw_91
  s_sub_u32 s50, s42, 5
  s_lshl_b32 s50, s50, 6
  v_xor_b32 v8, s50, v6
  v_add_u32 v8, 32768, v8
  s_cmp_eq_u32 s42, 7
  s_mov_b32 s51, 1024
  s_cselect_b32 s54, s51, 2048
  s_cselect_b32 s51, 512, s51
  s_cselect_b64 vcc, -1, 0
  v_cndmask_b32 v8, v8, v4, vcc
  v_add_u32 v9, s51, v8
  v_mov_b32 v48, 0
  v_mov_b32 v49, 0
  v_mov_b32 v50, 0
  v_mov_b32 v51, 0
  v_mov_b32 v11, 0x3f803f80
  ds_read_b64_tr_b16 v[16:17], v8
  ds_read_b64_tr_b16 v[18:19], v9
  v_add_u32 v8, s54, v8
  v_add_u32 v9, s54, v9
  ds_read_b64_tr_b16 v[20:21], v8
  ds_read_b64_tr_b16 v[22:23], v9
  v_add_u32 v8, s54, v8
  v_add_u32 v9, s54, v9
  ds_read_b64_tr_b16 v[24:25], v8
  ds_read_b64_tr_b16 v[26:27], v9
  v_add_u32 v8, s54, v8
  v_add_u32 v9, s54, v9
  ds_read_b64_tr_b16 v[28:29], v8
  ds_read_b64_tr_b16 v[30:31], v9
  v_add_u32 v8, s54, v8
  v_add_u32 v9, s54, v9
  ds_read_b64_tr_b16 v[32:33], v8
  ds_read_b64_tr_b16 v[34:35], v9
  v_add_u32 v8, s54, v8
  v_add_u32 v9, s54, v9
  ds_read_b64_tr_b16 v[36:37], v8
  ds_read_b64_tr_b16 v[38:39], v9
  v_add_u32 v8, s54, v8
  v_add_u32 v9, s54, v9
  ds_read_b64_tr_b16 v[40:41], v8
  ds_read_b64_tr_b16 v[42:43], v9
  v_add_u32 v8, s54, v8
  v_add_u32 v9, s54, v9
  ds_read_b64_tr_b16 v[44:45], v8
  ds_read_b64_tr_b16 v[46:47], v9
  v_add_u32 v8, s54, v8
  v_add_u32 v9, s54, v9
  s_waitcnt lgkmcnt(14)
  v_dot2c_f32_bf16 v48, v16, v11
  v_dot2c_f32_bf16 v49, v17, v11
  v_dot2c_f32_bf16 v50, v18, v11
  v_dot2c_f32_bf16 v51, v19, v11
  s_waitcnt lgkmcnt(12)
  v_dot2c_f32_bf16 v48, v20, v11
  v_dot2c_f32_bf16 v49, v21, v11
  v_dot2c_f32_bf16 v50, v22, v11
  v_dot2c_f32_bf16 v51, v23, v11
  s_waitcnt lgkmcnt(10)
  v_dot2c_f32_bf16 v48, v24, v11
  v_dot2c_f32_bf16 v49, v25, v11
  v_dot2c_f32_bf16 v50, v26, v11
  v_dot2c_f32_bf16 v51, v27, v11
  s_waitcnt lgkmcnt(8)
  v_dot2c_f32_bf16 v48, v28, v11
  v_dot2c_f32_bf16 v49, v29, v11
  v_dot2c_f32_bf16 v50, v30, v11
  v_dot2c_f32_bf16 v51, v31, v11
  ds_read_b64_tr_b16 v[16:17], v8
  ds_read_b64_tr_b16 v[18:19], v9
  v_add_u32 v8, s54, v8
  v_add_u32 v9, s54, v9
  ds_read_b64_tr_b16 v[20:21], v8
  ds_read_b64_tr_b16 v[22:23], v9
  v_add_u32 v8, s54, v8
  v_add_u32 v9, s54, v9
  ds_read_b64_tr_b16 v[24:25], v8
  ds_read_b64_tr_b16 v[26:27], v9
  v_add_u32 v8, s54, v8
  v_add_u32 v9, s54, v9
  ds_read_b64_tr_b16 v[28:29], v8
  ds_read_b64_tr_b16 v[30:31], v9
  v_add_u32 v8, s54, v8
  v_add_u32 v9, s54, v9
  s_waitcnt lgkmcnt(14)
  v_dot2c_f32_bf16 v48, v32, v11
  v_dot2c_f32_bf16 v49, v33, v11
  v_dot2c_f32_bf16 v50, v34, v11
  v_dot2c_f32_bf16 v51, v35, v11
  s_waitcnt lgkmcnt(12)
  v_dot2c_f32_bf16 v48, v36, v11
  v_dot2c_f32_bf16 v49, v37, v11
  v_dot2c_f32_bf16 v50, v38, v11
  v_dot2c_f32_bf16 v51, v39, v11
  s_waitcnt lgkmcnt(10)
  v_dot2c_f32_bf16 v48, v40, v11
  v_dot2c_f32_bf16 v49, v41, v11
  v_dot2c_f32_bf16 v50, v42, v11
  v_dot2c_f32_bf16 v51, v43, v11
  s_waitcnt lgkmcnt(8)
  v_dot2c_f32_bf16 v48, v44, v11
  v_dot2c_f32_bf16 v49, v45, v11
  v_dot2c_f32_bf16 v50, v46, v11
  v_dot2c_f32_bf16 v51, v47, v11
  ds_read_b64_tr_b16 v[32:33], v8
  ds_read_b64_tr_b16 v[34:35], v9
  v_add_u32 v8, s54, v8
  v_add_u32 v9, s54, v9
  ds_read_b64_tr_b16 v[36:37], v8
  ds_read_b64_tr_b16 v[38:39], v9
  v_add_u32 v8, s54, v8
  v_add_u32 v9, s54, v9
  ds_read_b64_tr_b16 v[40:41], v8
  ds_read_b64_tr_b16 v[42:43], v9
  v_add_u32 v8, s54, v8
  v_add_u32 v9, s54, v9
  ds_read_b64_tr_b16 v[44:45], v8
  ds_read_b64_tr_b16 v[46:47], v9
  v_add_u32 v8, s54, v8
  v_add_u32 v9, s54, v9
  s_waitcnt lgkmcnt(14)
  v_dot2c_f32_bf16 v48, v16, v11
  v_dot2c_f32_bf16 v49, v17, v11
  v_dot2c_f32_bf16 v50, v18, v11
  v_dot2c_f32_bf16 v51, v19, v11
  s_waitcnt lgkmcnt(12)
  v_dot2c_f32_bf16 v48, v20, v11
  v_dot2c_f32_bf16 v49, v21, v11
  v_dot2c_f32_bf16 v50, v22, v11
  v_dot2c_f32_bf16 v51, v23, v11
  s_waitcnt lgkmcnt(10)
  v_dot2c_f32_bf16 v48, v24, v11
  v_dot2c_f32_bf16 v49, v25, v11
  v_dot2c_f32_bf16 v50, v26, v11
  v_dot2c_f32_bf16 v51, v27, v11
  s_waitcnt lgkmcnt(8)
  v_dot2c_f32_bf16 v48, v28, v11
  v_dot2c_f32_bf16 v49, v29, v11
  v_dot2c_f32_bf16 v50, v30, v11
  v_dot2c_f32_bf16 v51, v31, v11
  ds_read_b64_tr_b16 v[16:17], v8
  ds_read_b64_tr_b16 v[18:19], v9
  v_add_u32 v8, s54, v8
  v_add_u32 v9, s54, v9
  ds_read_b64_tr_b16 v[20:21], v8
  ds_read_b64_tr_b16 v[22:23], v9
  v_add_u32 v8, s54, v8
  v_add_u32 v9, s54, v9
  ds_read_b64_tr_b16 v[24:25], v8
  ds_read_b64_tr_b16 v[26:27], v9
  v_add_u32 v8, s54, v8
  v_add_u32 v9, s54, v9
  ds_read_b64_tr_b16 v[28:29], v8
  ds_read_b64_tr_b16 v[30:31], v9
  v_add_u32 v8, s54, v8
  v_add_u32 v9, s54, v9
  s_waitcnt lgkmcnt(14)
  v_dot2c_f32_bf16 v48, v32, v11
  v_dot2c_f32_bf16 v49, v33, v11
  v_dot2c_f32_bf16 v50, v34, v11
  v_dot2c_f32_bf16 v51, v35, v11
  s_waitcnt lgkmcnt(12)
  v_dot2c_f32_bf16 v48, v36, v11
  v_dot2c_f32_bf16 v49, v37, v11
  v_dot2c_f32_bf16 v50, v38, v11
  v_dot2c_f32_bf16 v51, v39, v11
  s_waitcnt lgkmcnt(10)
  v_dot2c_f32_bf16 v48, v40, v11
  v_dot2c_f32_bf16 v49, v41, v11
  v_dot2c_f32_bf16 v50, v42, v11
  v_dot2c_f32_bf16 v51, v43, v11
  s_waitcnt lgkmcnt(8)
  v_dot2c_f32_bf16 v48, v44, v11
  v_dot2c_f32_bf16 v49, v45, v11
  v_dot2c_f32_bf16 v50, v46, v11
  v_dot2c_f32_bf16 v51, v47, v11
  ds_read_b64_tr_b16 v[32:33], v8
  ds_read_b64_tr_b16 v[34:35], v9
  v_add_u32 v8, s54, v8
  v_add_u32 v9, s54, v9
  ds_read_b64_tr_b16 v[36:37], v8
  ds_read_b64_tr_b16 v[38:39], v9
  v_add_u32 v8, s54, v8
  v_add_u32 v9, s54, v9
  ds_read_b64_tr_b16 v[40:41], v8
  ds_read_b64_tr_b16 v[42:43], v9
  v_add_u32 v8, s54, v8
  v_add_u32 v9, s54, v9
  ds_read_b64_tr_b16 v[44:45], v8
  ds_read_b64_tr_b16 v[46:47], v9
  v_add_u32 v8, s54, v8
  v_add_u32 v9, s54, v9
  s_waitcnt lgkmcnt(14)
  v_dot2c_f32_bf16 v48, v16, v11
  v_dot2c_f32_bf16 v49, v17, v11
  v_dot2c_f32_bf16 v50, v18, v11
  v_dot2c_f32_bf16 v51, v19, v11
  s_waitcnt lgkmcnt(12)
  v_dot2c_f32_bf16 v48, v20, v11
  v_dot2c_f32_bf16 v49, v21, v11
  v_dot2c_f32_bf16 v50, v22, v11
  v_dot2c_f32_bf16 v51, v23, v11
  s_waitcnt lgkmcnt(10)
  v_dot2c_f32_bf16 v48, v24, v11
  v_dot2c_f32_bf16 v49, v25, v11
  v_dot2c_f32_bf16 v50, v26, v11
  v_dot2c_f32_bf16 v51, v27, v11
  s_waitcnt lgkmcnt(8)
  v_dot2c_f32_bf16 v48, v28, v11
  v_dot2c_f32_bf16 v49, v29, v11
  v_dot2c_f32_bf16 v50, v30, v11
  v_dot2c_f32_bf16 v51, v31, v11
  ds_read_b64_tr_b16 v[16:17], v8
  ds_read_b64_tr_b16 v[18:19], v9
  v_add_u32 v8, s54, v8
  v_add_u32 v9, s54, v9
  ds_read_b64_tr_b16 v[20:21], v8
  ds_read_b64_tr_b16 v[22:23], v9
  v_add_u32 v8, s54, v8
  v_add_u32 v9, s54, v9
  ds_read_b64_tr_b16 v[24:25], v8
  ds_read_b64_tr_b16 v[26:27], v9
  v_add_u32 v8, s54, v8
  v_add_u32 v9, s54, v9
  ds_read_b64_tr_b16 v[28:29], v8
  ds_read_b64_tr_b16 v[30:31], v9
  v_add_u32 v8, s54, v8
  v_add_u32 v9, s54, v9
  s_waitcnt lgkmcnt(14)
  v_dot2c_f32_bf16 v48, v32, v11
  v_dot2c_f32_bf16 v49, v33, v11
  v_dot2c_f32_bf16 v50, v34, v11
  v_dot2c_f32_bf16 v51, v35, v11
  s_waitcnt lgkmcnt(12)
  v_dot2c_f32_bf16 v48, v36, v11
  v_dot2c_f32_bf16 v49, v37, v11
  v_dot2c_f32_bf16 v50, v38, v11
  v_dot2c_f32_bf16 v51, v39, v11
  s_waitcnt lgkmcnt(10)
  v_dot2c_f32_bf16 v48, v40, v11
  v_dot2c_f32_bf16 v49, v41, v11
  v_dot2c_f32_bf16 v50, v42, v11
  v_dot2c_f32_bf16 v51, v43, v11
  s_waitcnt lgkmcnt(8)
  v_dot2c_f32_bf16 v48, v44, v11
  v_dot2c_f32_bf16 v49, v45, v11
  v_dot2c_f32_bf16 v50, v46, v11
  v_dot2c_f32_bf16 v51, v47, v11
  ds_read_b64_tr_b16 v[32:33], v8
  ds_read_b64_tr_b16 v[34:35], v9
  v_add_u32 v8, s54, v8
  v_add_u32 v9, s54, v9
  ds_read_b64_tr_b16 v[36:37], v8
  ds_read_b64_tr_b16 v[38:39], v9
  v_add_u32 v8, s54, v8
  v_add_u32 v9, s54, v9
  ds_read_b64_tr_b16 v[40:41], v8
  ds_read_b64_tr_b16 v[42:43], v9
  v_add_u32 v8, s54, v8
  v_add_u32 v9, s54, v9
  ds_read_b64_tr_b16 v[44:45], v8
  ds_read_b64_tr_b16 v[46:47], v9
  v_add_u32 v8, s54, v8
  v_add_u32 v9, s54, v9
  s_waitcnt lgkmcnt(14)
  v_dot2c_f32_bf16 v48, v16, v11
  v_dot2c_f32_bf16 v49, v17, v11
  v_dot2c_f32_bf16 v50, v18, v11
  v_dot2c_f32_bf16 v51, v19, v11
  s_waitcnt lgkmcnt(12)
  v_dot2c_f32_bf16 v48, v20, v11
  v_dot2c_f32_bf16 v49, v21, v11
  v_dot2c_f32_bf16 v50, v22, v11
  v_dot2c_f32_bf16 v51, v23, v11
  s_waitcnt lgkmcnt(10)
  v_dot2c_f32_bf16 v48, v24, v11
  v_dot2c_f32_bf16 v49, v25, v11
  v_dot2c_f32_bf16 v50, v26, v11
  v_dot2c_f32_bf16 v51, v27, v11
  s_waitcnt lgkmcnt(8)
  v_dot2c_f32_bf16 v48, v28, v11
  v_dot2c_f32_bf16 v49, v29, v11
  v_dot2c_f32_bf16 v50, v30, v11
  v_dot2c_f32_bf16 v51, v31, v11
  s_waitcnt lgkmcnt(6)
  v_dot2c_f32_bf16 v48, v32, v11
  v_dot2c_f32_bf16 v49, v33, v11
  v_dot2c_f32_bf16 v50, v34, v11
  v_dot2c_f32_bf16 v51, v35, v11
  s_waitcnt lgkmcnt(4)
  v_dot2c_f32_bf16 v48, v36, v11
  v_dot2c_f32_bf16 v49, v37, v11
  v_dot2c_f32_bf16 v50, v38, v11
  v_dot2c_f32_bf16 v51, v39, v11
  s_waitcnt lgkmcnt(2)
  v_dot2c_f32_bf16 v48, v40, v11
  v_dot2c_f32_bf16 v49, v41, v11
  v_dot2c_f32_bf16 v50, v42, v11
  v_dot2c_f32_bf16 v51, v43, v11
  s_waitcnt lgkmcnt(0)
  v_dot2c_f32_bf16 v48, v44, v11
  v_dot2c_f32_bf16 v49, v45, v11
  v_dot2c_f32_bf16 v50, v46, v11
  v_dot2c_f32_bf16 v51, v47, v11
  s_nop 0
  v_add_f32 v48, v48, v49
  s_nop 0
  v_add_f32 v50, v50, v51
  v_add_f32 v9, v48, v50
  v_mov_b32 v10, v9
  s_nop 1
  v_permlane32_swap_b32 v9, v10
  v_add_f32 v241, v9, v10
  v_lshlrev_b32 v13, 16, v247
  v_mul_f32 v242, 0xbeeff558, v13
Lcsw_91:
  s_sub_u32 s60, s42, 4
  s_cmp_eq_u32 s42, 7
  s_cselect_b32 s60, 0, s60
  s_lshl_b32 s50, s60, 7
  s_add_u32 s50, s50, 162816
  v_and_b32 v12, 31, v1
  v_lshlrev_b32 v12, 2, v12
  v_add_u32 v12, s50, v12
  ds_write_b32 v12, v241
  ds_write_b32 v12, v242 offset:384
  s_waitcnt lgkmcnt(0)
Lm4_90:
  s_barrier
  v_lshrrev_b32 v14, 3, v1
  v_mul_u32_u24 v14, 1024, v14
  v_bfe_u32 v15, v1, 4, 1
  v_lshlrev_b32 v15, 2, v15
  v_xor_b32 v15, v15, v1
  v_and_b32 v15, 7, v15
  v_lshl_add_u32 v8, v15, 4, v14
  s_sub_u32 s50, s42, 4
  s_lshr_b32 s51, s50, 1
  s_mul_i32 s51, s51, 43
  s_add_u32 s51, s51, 0
  s_and_b32 s52, s50, 1
  s_and_b32 s53, s41, 7
  s_lshl_b32 s51, s51, 14
  s_lshl_b32 s83, s52, 13
  s_add_u32 s51, s51, s83
  s_lshl_b32 s83, s53, 7
  s_add_u32 s51, s51, s83
  s_lshl_b32 s52, s50, 10
  s_add_u32 s52, s52, 98304
  s_lshr_b32 s53, s41, 3
  s_mul_i32 s53, s53, 15
  s_lshr_b32 s53, s53, 2
  s_mov_b32 s73, s53
  s_mul_i32 s74, s73, 16384
  s_mul_i32 s75, s73, 4096
  s_add_u32 s74, s74, s51
  s_add_u32 s75, s75, s52
  s_mov_b32 m0, s75
  s_add_u32 s73, s73, 1
  buffer_load_dwordx4 v8, s[20:23], s74 offen lds
  s_cmp_eq_u32 s73, 15
  s_cselect_b32 s73, 0, s73
  s_mul_i32 s74, s73, 16384
  s_mul_i32 s75, s73, 4096
  s_add_u32 s74, s74, s51
  s_add_u32 s75, s75, s52
  s_mov_b32 m0, s75
  s_add_u32 s73, s73, 1
  buffer_load_dwordx4 v8, s[20:23], s74 offen lds
  s_cmp_eq_u32 s73, 15
  s_cselect_b32 s73, 0, s73
  s_mul_i32 s74, s73, 16384
  s_mul_i32 s75, s73, 4096
  s_add_u32 s74, s74, s51
  s_add_u32 s75, s75, s52
  s_mov_b32 m0, s75
  s_add_u32 s73, s73, 1
  buffer_load_dwordx4 v8, s[20:23], s74 offen lds
  s_cmp_eq_u32 s73, 15
  s_cselect_b32 s73, 0, s73
  s_mul_i32 s74, s73, 16384
  s_mul_i32 s75, s73, 4096
  s_add_u32 s74, s74, s51
  s_add_u32 s75, s75, s52
  s_mov_b32 m0, s75
  s_add_u32 s73, s73, 1
  buffer_load_dwordx4 v8, s[20:23], s74 offen lds
  s_cmp_eq_u32 s73, 15
  s_cselect_b32 s73, 0, s73
  s_mul_i32 s74, s73, 16384
  s_mul_i32 s75, s73, 4096
  s_add_u32 s74, s74, s51
  s_add_u32 s75, s75, s52
  s_mov_b32 m0, s75
  s_add_u32 s73, s73, 1
  buffer_load_dwordx4 v8, s[20:23], s74 offen lds
  s_cmp_eq_u32 s73, 15
  s_cselect_b32 s73, 0, s73
  s_mul_i32 s74, s73, 16384
  s_mul_i32 s75, s73, 4096
  s_add_u32 s74, s74, s51
  s_add_u32 s75, s75, s52
  s_mov_b32 m0, s75
  s_add_u32 s73, s73, 1
  buffer_load_dwordx4 v8, s[20:23], s74 offen lds
  s_cmp_eq_u32 s73, 15
  s_cselect_b32 s73, 0, s73
  s_mul_i32 s74, s73, 16384
  s_mul_i32 s75, s73, 4096
  s_add_u32 s74, s74, s51
  s_add_u32 s75, s75, s52
  s_mov_b32 m0, s75
  s_add_u32 s73, s73, 1
  buffer_load_dwordx4 v8, s[20:23], s74 offen lds
  s_cmp_eq_u32 s73, 15
  s_cselect_b32 s73, 0, s73
  s_mul_i32 s74, s73, 16384
  s_mul_i32 s75, s73, 4096
  s_add_u32 s74, s74, s51
  s_add_u32 s75, s75, s52
  s_mov_b32 m0, s75
  s_add_u32 s73, s73, 1
  buffer_load_dwordx4 v8, s[20:23], s74 offen lds
  s_cmp_eq_u32 s73, 15
  s_cselect_b32 s73, 0, s73
  s_mul_i32 s74, s73, 16384
  s_mul_i32 s75, s73, 4096
  s_add_u32 s74, s74, s51
  s_add_u32 s75, s75, s52
  s_mov_b32 m0, s75
  s_add_u32 s73, s73, 1
  buffer_load_dwordx4 v8, s[20:23], s74 offen lds
  s_cmp_eq_u32 s73, 15
  s_cselect_b32 s73, 0, s73
  s_mul_i32 s74, s73, 16384
  s_mul_i32 s75, s73, 4096
  s_add_u32 s74, s74, s51
  s_add_u32 s75, s75, s52
  s_mov_b32 m0, s75
  s_add_u32 s73, s73, 1
  buffer_load_dwordx4 v8, s[20:23], s74 offen lds
  s_cmp_eq_u32 s73, 15
  s_cselect_b32 s73, 0, s73
  s_mul_i32 s74, s73, 16384
  s_mul_i32 s75, s73, 4096
  s_add_u32 s74, s74, s51
  s_add_u32 s75, s75, s52
  s_mov_b32 m0, s75
  s_add_u32 s73, s73, 1
  buffer_load_dwordx4 v8, s[20:23], s74 offen lds
  s_cmp_eq_u32 s73, 15
  s_cselect_b32 s73, 0, s73
  s_mul_i32 s74, s73, 16384
  s_mul_i32 s75, s73, 4096
  s_add_u32 s74, s74, s51
  s_add_u32 s75, s75, s52
  s_mov_b32 m0, s75
  s_add_u32 s73, s73, 1
  buffer_load_dwordx4 v8, s[20:23], s74 offen lds
  s_cmp_eq_u32 s73, 15
  s_cselect_b32 s73, 0, s73
  s_mul_i32 s74, s73, 16384
  s_mul_i32 s75, s73, 4096
  s_add_u32 s74, s74, s51
  s_add_u32 s75, s75, s52
  s_mov_b32 m0, s75
  s_add_u32 s73, s73, 1
  buffer_load_dwordx4 v8, s[20:23], s74 offen lds
  s_cmp_eq_u32 s73, 15
  s_cselect_b32 s73, 0, s73
  s_mul_i32 s74, s73, 16384
  s_mul_i32 s75, s73, 4096
  s_add_u32 s74, s74, s51
  s_add_u32 s75, s75, s52
  s_mov_b32 m0, s75
  s_add_u32 s73, s73, 1
  buffer_load_dwordx4 v8, s[20:23], s74 offen lds
  s_cmp_eq_u32 s73, 15
  s_cselect_b32 s73, 0, s73
  s_mul_i32 s74, s73, 16384
  s_mul_i32 s75, s73, 4096
  s_add_u32 s74, s74, s51
  s_add_u32 s75, s75, s52
  s_mov_b32 m0, s75
  s_add_u32 s73, s73, 1
  buffer_load_dwordx4 v8, s[20:23], s74 offen lds
  s_barrier
  v_lshrrev_b32 v14, 3, v1
  v_mul_u32_u24 v14, 1024, v14
  v_bfe_u32 v15, v1, 4, 1
  v_lshlrev_b32 v15, 2, v15
  v_xor_b32 v15, v15, v1
  v_and_b32 v15, 7, v15
  v_lshl_add_u32 v8, v15, 4, v14
  s_sub_u32 s50, s42, 4
  s_lshr_b32 s51, s50, 1
  s_mul_i32 s51, s51, 43
  s_add_u32 s51, s51, 15
  s_and_b32 s52, s50, 1
  s_and_b32 s53, s41, 7
  s_lshl_b32 s51, s51, 14
  s_lshl_b32 s83, s52, 13
  s_add_u32 s51, s51, s83
  s_lshl_b32 s83, s53, 7
  s_add_u32 s51, s51, s83
  s_lshl_b32 s52, s50, 10
  s_lshr_b32 s53, s41, 3
  s_mul_i32 s53, s53, 16
  s_lshr_b32 s53, s53, 2
  s_mov_b32 s73, s53
  s_mul_i32 s74, s73, 16384
  s_mul_i32 s75, s73, 4096
  s_add_u32 s74, s74, s51
  s_add_u32 s75, s75, s52
  s_mov_b32 m0, s75
  s_add_u32 s73, s73, 1
  buffer_load_dwordx4 v8, s[20:23], s74 offen lds
  s_cmp_eq_u32 s73, 16
  s_cselect_b32 s73, 0, s73
  s_mul_i32 s74, s73, 16384
  s_mul_i32 s75, s73, 4096
  s_add_u32 s74, s74, s51
  s_add_u32 s75, s75, s52
  s_mov_b32 m0, s75
  s_add_u32 s73, s73, 1
  buffer_load_dwordx4 v8, s[20:23], s74 offen lds
  s_cmp_eq_u32 s73, 16
  s_cselect_b32 s73, 0, s73
  s_mul_i32 s74, s73, 16384
  s_mul_i32 s75, s73, 4096
  s_add_u32 s74, s74, s51
  s_add_u32 s75, s75, s52
  s_mov_b32 m0, s75
  s_add_u32 s73, s73, 1
  buffer_load_dwordx4 v8, s[20:23], s74 offen lds
  s_cmp_eq_u32 s73, 16
  s_cselect_b32 s73, 0, s73
  s_mul_i32 s74, s73, 16384
  s_mul_i32 s75, s73, 4096
  s_add_u32 s74, s74, s51
  s_add_u32 s75, s75, s52
  s_mov_b32 m0, s75
  s_add_u32 s73, s73, 1
  buffer_load_dwordx4 v8, s[20:23], s74 offen lds
  s_cmp_eq_u32 s73, 16
  s_cselect_b32 s73, 0, s73
  s_mul_i32 s74, s73, 16384
  s_mul_i32 s75, s73, 4096
  s_add_u32 s74, s74, s51
  s_add_u32 s75, s75, s52
  s_mov_b32 m0, s75
  s_add_u32 s73, s73, 1
  buffer_load_dwordx4 v8, s[20:23], s74 offen lds
  s_cmp_eq_u32 s73, 16
  s_cselect_b32 s73, 0, s73
  s_mul_i32 s74, s73, 16384
  s_mul_i32 s75, s73, 4096
  s_add_u32 s74, s74, s51
  s_add_u32 s75, s75, s52
  s_mov_b32 m0, s75
  s_add_u32 s73, s73, 1
  buffer_load_dwordx4 v8, s[20:23], s74 offen lds
  s_cmp_eq_u32 s73, 16
  s_cselect_b32 s73, 0, s73
  s_mul_i32 s74, s73, 16384
  s_mul_i32 s75, s73, 4096
  s_add_u32 s74, s74, s51
  s_add_u32 s75, s75, s52
  s_mov_b32 m0, s75
  s_add_u32 s73, s73, 1
  buffer_load_dwordx4 v8, s[20:23], s74 offen lds
  s_cmp_eq_u32 s73, 16
  s_cselect_b32 s73, 0, s73
  s_mul_i32 s74, s73, 16384
  s_mul_i32 s75, s73, 4096
  s_add_u32 s74, s74, s51
  s_add_u32 s75, s75, s52
  s_mov_b32 m0, s75
  s_add_u32 s73, s73, 1
  buffer_load_dwordx4 v8, s[20:23], s74 offen lds
  s_cmp_eq_u32 s73, 16
  s_cselect_b32 s73, 0, s73
  s_mul_i32 s74, s73, 16384
  s_mul_i32 s75, s73, 4096
  s_add_u32 s74, s74, s51
  s_add_u32 s75, s75, s52
  s_mov_b32 m0, s75
  s_add_u32 s73, s73, 1
  buffer_load_dwordx4 v8, s[20:23], s74 offen lds
  s_cmp_eq_u32 s73, 16
  s_cselect_b32 s73, 0, s73
  s_mul_i32 s74, s73, 16384
  s_mul_i32 s75, s73, 4096
  s_add_u32 s74, s74, s51
  s_add_u32 s75, s75, s52
  s_mov_b32 m0, s75
  s_add_u32 s73, s73, 1
  buffer_load_dwordx4 v8, s[20:23], s74 offen lds
  s_cmp_eq_u32 s73, 16
  s_cselect_b32 s73, 0, s73
  s_mul_i32 s74, s73, 16384
  s_mul_i32 s75, s73, 4096
  s_add_u32 s74, s74, s51
  s_add_u32 s75, s75, s52
  s_mov_b32 m0, s75
  s_add_u32 s73, s73, 1
  buffer_load_dwordx4 v8, s[20:23], s74 offen lds
  s_cmp_eq_u32 s73, 16
  s_cselect_b32 s73, 0, s73
  s_mul_i32 s74, s73, 16384
  s_mul_i32 s75, s73, 4096
  s_add_u32 s74, s74, s51
  s_add_u32 s75, s75, s52
  s_mov_b32 m0, s75
  s_add_u32 s73, s73, 1
  buffer_load_dwordx4 v8, s[20:23], s74 offen lds
  s_cmp_eq_u32 s73, 16
  s_cselect_b32 s73, 0, s73
  s_mul_i32 s74, s73, 16384
  s_mul_i32 s75, s73, 4096
  s_add_u32 s74, s74, s51
  s_add_u32 s75, s75, s52
  s_mov_b32 m0, s75
  s_add_u32 s73, s73, 1
  buffer_load_dwordx4 v8, s[20:23], s74 offen lds
  s_cmp_eq_u32 s73, 16
  s_cselect_b32 s73, 0, s73
  s_mul_i32 s74, s73, 16384
  s_mul_i32 s75, s73, 4096
  s_add_u32 s74, s74, s51
  s_add_u32 s75, s75, s52
  s_mov_b32 m0, s75
  s_add_u32 s73, s73, 1
  buffer_load_dwordx4 v8, s[20:23], s74 offen lds
  s_cmp_eq_u32 s73, 16
  s_cselect_b32 s73, 0, s73
  s_mul_i32 s74, s73, 16384
  s_mul_i32 s75, s73, 4096
  s_add_u32 s74, s74, s51
  s_add_u32 s75, s75, s52
  s_mov_b32 m0, s75
  s_add_u32 s73, s73, 1
  buffer_load_dwordx4 v8, s[20:23], s74 offen lds
  s_cmp_eq_u32 s73, 16
  s_cselect_b32 s73, 0, s73
  s_mul_i32 s74, s73, 16384
  s_mul_i32 s75, s73, 4096
  s_add_u32 s74, s74, s51
  s_add_u32 s75, s75, s52
  s_mov_b32 m0, s75
  s_add_u32 s73, s73, 1
  buffer_load_dwordx4 v8, s[20:23], s74 offen lds
  s_barrier
  v_lshrrev_b32 v14, 3, v1
  v_mul_u32_u24 v14, 1024, v14
  v_bfe_u32 v15, v1, 4, 1
  v_lshlrev_b32 v15, 2, v15
  v_xor_b32 v15, v15, v1
  v_and_b32 v15, 7, v15
  v_lshl_add_u32 v8, v15, 4, v14
  s_sub_u32 s50, s42, 4
  s_lshr_b32 s51, s50, 1
  s_mul_i32 s51, s51, 43
  s_add_u32 s51, s51, 31
  s_and_b32 s52, s50, 1
  s_and_b32 s53, s41, 7
  s_lshl_b32 s51, s51, 14
  s_lshl_b32 s83, s52, 13
  s_add_u32 s51, s51, s83
  s_lshl_b32 s83, s53, 7
  s_add_u32 s51, s51, s83
  s_lshl_b32 s52, s50, 10
  s_add_u32 s52, s52, 65536
  s_lshr_b32 s53, s41, 3
  s_mul_i32 s53, s53, 8
  s_lshr_b32 s53, s53, 2
  s_mov_b32 s73, s53
  s_mul_i32 s74, s73, 16384
  s_mul_i32 s75, s73, 4096
  s_add_u32 s74, s74, s51
  s_add_u32 s75, s75, s52
  s_mov_b32 m0, s75
  s_add_u32 s73, s73, 1
  buffer_load_dwordx4 v8, s[20:23], s74 offen lds
  s_cmp_eq_u32 s73, 8
  s_cselect_b32 s73, 0, s73
  s_mul_i32 s74, s73, 16384
  s_mul_i32 s75, s73, 4096
  s_add_u32 s74, s74, s51
  s_add_u32 s75, s75, s52
  s_mov_b32 m0, s75
  s_add_u32 s73, s73, 1
  buffer_load_dwordx4 v8, s[20:23], s74 offen lds
  s_cmp_eq_u32 s73, 8
  s_cselect_b32 s73, 0, s73
  s_mul_i32 s74, s73, 16384
  s_mul_i32 s75, s73, 4096
  s_add_u32 s74, s74, s51
  s_add_u32 s75, s75, s52
  s_mov_b32 m0, s75
  s_add_u32 s73, s73, 1
  buffer_load_dwordx4 v8, s[20:23], s74 offen lds
  s_cmp_eq_u32 s73, 8
  s_cselect_b32 s73, 0, s73
  s_mul_i32 s74, s73, 16384
  s_mul_i32 s75, s73, 4096
  s_add_u32 s74, s74, s51
  s_add_u32 s75, s75, s52
  s_mov_b32 m0, s75
  s_add_u32 s73, s73, 1
  buffer_load_dwordx4 v8, s[20:23], s74 offen lds
  s_cmp_eq_u32 s73, 8
  s_cselect_b32 s73, 0, s73
  s_mul_i32 s74, s73, 16384
  s_mul_i32 s75, s73, 4096
  s_add_u32 s74, s74, s51
  s_add_u32 s75, s75, s52
  s_mov_b32 m0, s75
  s_add_u32 s73, s73, 1
  buffer_load_dwordx4 v8, s[20:23], s74 offen lds
  s_cmp_eq_u32 s73, 8
  s_cselect_b32 s73, 0, s73
  s_mul_i32 s74, s73, 16384
  s_mul_i32 s75, s73, 4096
  s_add_u32 s74, s74, s51
  s_add_u32 s75, s75, s52
  s_mov_b32 m0, s75
  s_add_u32 s73, s73, 1
  buffer_load_dwordx4 v8, s[20:23], s74 offen lds
  s_cmp_eq_u32 s73, 8
  s_cselect_b32 s73, 0, s73
  s_mul_i32 s74, s73, 16384
  s_mul_i32 s75, s73, 4096
  s_add_u32 s74, s74, s51
  s_add_u32 s75, s75, s52
  s_mov_b32 m0, s75
  s_add_u32 s73, s73, 1
  buffer_load_dwordx4 v8, s[20:23], s74 offen lds
  s_cmp_eq_u32 s73, 8
  s_cselect_b32 s73, 0, s73
  s_mul_i32 s74, s73, 16384
  s_mul_i32 s75, s73, 4096
  s_add_u32 s74, s74, s51
  s_add_u32 s75, s75, s52
  s_mov_b32 m0, s75
  s_add_u32 s73, s73, 1
  buffer_load_dwordx4 v8, s[20:23], s74 offen lds
  s_waitcnt vmcnt(24)
  s_barrier
L_mlp1_d:
  s_cmp_ge_u32 s42, 4
  s_cbranch_scc1 L_mlp2_h
  s_lshr_b32 s50, s41, 3
  s_and_b32 s51, s42, 1
  s_lshl_b32 s50, s50, 1
  s_add_u32 s50, s50, s51
  s_lshl_b32 s82, s40, 3
  s_add_u32 s82, s82, s50
  s_lshr_b32 s51, s42, 1
  s_and_b32 s52, s41, 7
  s_lshl_b32 s52, s52, 1
  s_add_u32 s52, s52, s51
  s_lshl_b32 s66, s82, 15
  s_lshl_b32 s83, s52, 11
  s_add_u32 s66, s66, s83
  s_lshr_b32 s69, s52, 2
  s_and_b32 s70, s52, 3
  s_lshl_b32 s67, s82, 12
  s_lshl_b32 s83, s69, 10
  s_add_u32 s67, s67, s83
  s_lshl_b32 s83, s70, 2
  s_add_u32 s67, s67, s83
  s_add_u32 s67, s67, 8388608
  s_lshl_b32 s68, s82, 4
  s_add_u32 s68, s68, s52
  s_lshl_b32 s68, s68, 7
  s_add_u32 s68, s68, s46
  s_add_u32 s68, s68, 18350080
  s_lshl_b32 s55, s52, 6
  s_buffer_load_dwordx16 s[84:99], s[36:39], s55
  v_cmp_eq_u32 vcc, 0, v5
  s_waitcnt lgkmcnt(0)
  v_mov_b32 v24, s86
  v_mov_b32 v12, s84
  v_cndmask_b32 v24, v24, v12, vcc
  v_mov_b32 v25, s87
  v_mov_b32 v12, s85
  v_cndmask_b32 v25, v25, v12, vcc
  v_mov_b32 v26, s90
  v_mov_b32 v12, s88
  v_cndmask_b32 v26, v26, v12, vcc
  v_mov_b32 v27, s91
  v_mov_b32 v12, s89
  v_cndmask_b32 v27, v27, v12, vcc
  v_mov_b32 v28, s94
  v_mov_b32 v12, s92
  v_cndmask_b32 v28, v28, v12, vcc
  v_mov_b32 v29, s95
  v_mov_b32 v12, s93
  v_cndmask_b32 v29, v29, v12, vcc
  v_mov_b32 v30, s98
  v_mov_b32 v12, s96
  v_cndmask_b32 v30, v30, v12, vcc
  v_mov_b32 v31, s99
  v_mov_b32 v12, s97
  v_cndmask_b32 v31, v31, v12, vcc
  s_lshl_b32 s69, s42, 12
  s_add_u32 s69, s69, 114688
  v_add_u32 v114, s69, v2
  s_xor_b32 s69, s42, 2
  s_lshl_b32 s69, s69, 12
  s_add_u32 s69, s69, 114688
  v_add_u32 v115, s69, v2
  s_lshl_b32 s56, s51, 11
  v_add_u32 v8, s56, v6
  s_lshl_b32 s57, s51, 6
  v_xor_b32 v8, s57, v8
  v_xor_b32 v116, 64, v8
  v_add_u32 v9, 0x10000, v8
  v_add_u32 v10, 98304, v8
  v_add_u32 v117, 0x10000, v116
  v_add_u32 v118, 98304, v116
  s_lshl_b32 s59, s82, 6
  s_add_u32 s59, s59, s46
  s_add_u32 s59, s59, 13918208
  s_mul_i32 s61, s82, 98304
  s_mul_i32 s62, s51, 44032
  s_mov_b32 s61, s61
  s_add_u32 s61, s61, s62
  s_add_u32 s61, s61, 2097152
  v_and_b32 v14, 15, v1
  v_lshlrev_b32 v14, 2, v14
  s_mov_b32 s79, 262144
  buffer_load_dword v15, v14, s[24:27], s59 offen sc1
  v_lshlrev_b32 v80, 16, v72
  v_and_b32 v81, 0xffff0000, v72
  v_lshlrev_b32 v82, 16, v73
  v_and_b32 v83, 0xffff0000, v73
  v_lshlrev_b32 v84, 16, v74
  v_and_b32 v85, 0xffff0000, v74
  v_lshlrev_b32 v86, 16, v75
  v_and_b32 v87, 0xffff0000, v75
  v_lshlrev_b32 v88, 16, v76
  v_and_b32 v89, 0xffff0000, v76
  v_lshlrev_b32 v90, 16, v77
  v_and_b32 v91, 0xffff0000, v77
  v_lshlrev_b32 v92, 16, v78
  v_and_b32 v93, 0xffff0000, v78
  v_lshlrev_b32 v94, 16, v79
  v_and_b32 v95, 0xffff0000, v79
  v_lshlrev_b32 v32, 16, v24
  v_and_b32 v33, 0xffff0000, v24
  v_lshlrev_b32 v34, 16, v25
  v_and_b32 v35, 0xffff0000, v25
  v_lshlrev_b32 v36, 16, v26
  v_and_b32 v37, 0xffff0000, v26
  v_lshlrev_b32 v38, 16, v27
  v_and_b32 v39, 0xffff0000, v27
  v_lshlrev_b32 v40, 16, v28
  v_and_b32 v41, 0xffff0000, v28
  v_lshlrev_b32 v42, 16, v29
  v_and_b32 v43, 0xffff0000, v29
  v_lshlrev_b32 v44, 16, v30
  v_and_b32 v45, 0xffff0000, v30
  v_lshlrev_b32 v46, 16, v31
  v_and_b32 v47, 0xffff0000, v31
  v_pk_add_f32 v[80:81], v[80:81], v[32:33]
  v_pk_mul_f32 v[80:81], v[80:81], s[80:81]
  v_pk_add_f32 v[82:83], v[82:83], v[34:35]
  v_pk_mul_f32 v[82:83], v[82:83], s[80:81]
  v_pk_add_f32 v[84:85], v[84:85], v[36:37]
  v_pk_mul_f32 v[84:85], v[84:85], s[80:81]
  v_pk_add_f32 v[86:87], v[86:87], v[38:39]
  v_pk_mul_f32 v[86:87], v[86:87], s[80:81]
  v_pk_add_f32 v[88:89], v[88:89], v[40:41]
  v_pk_mul_f32 v[88:89], v[88:89], s[80:81]
  v_pk_add_f32 v[90:91], v[90:91], v[42:43]
  v_pk_mul_f32 v[90:91], v[90:91], s[80:81]
  v_pk_add_f32 v[92:93], v[92:93], v[44:45]
  v_pk_mul_f32 v[92:93], v[92:93], s[80:81]
  v_pk_add_f32 v[94:95], v[94:95], v[46:47]
  v_pk_mul_f32 v[94:95], v[94:95], s[80:81]
  s_waitcnt vmcnt(0)
  v_cmp_ne_u32 vcc, s43, v15
  s_cbranch_vccz Lpolld_93
Lpoll_92:
  buffer_load_dword v15, v14, s[24:27], s59 offen sc1
  s_sub_u32 s79, s79, 1
  s_cbranch_scc1 Lpolld_93
  s_waitcnt vmcnt(0)
  v_cmp_ne_u32 vcc, s43, v15
  s_cbranch_vccnz Lpoll_92
Lpolld_93:
  s_waitcnt vmcnt(0)
  buffer_load_dwordx4 v[128:131], v2, s[24:27], s61 offen offset:0 sc1
  buffer_load_dwordx4 v[132:135], v2, s[24:27], s61 offen offset:1024 sc1
  buffer_load_dwordx4 v[136:139], v2, s[24:27], s61 offen offset:2048 sc1
  buffer_load_dwordx4 v[140:143], v2, s[24:27], s61 offen offset:3072 sc1
  s_add_u32 s61, s61, 4096
  buffer_load_dwordx4 v[144:147], v2, s[24:27], s61 offen offset:0 sc1
  buffer_load_dwordx4 v[148:151], v2, s[24:27], s61 offen offset:1024 sc1
  buffer_load_dwordx4 v[152:155], v2, s[24:27], s61 offen offset:2048 sc1
  buffer_load_dwordx4 v[156:159], v2, s[24:27], s61 offen offset:3072 sc1
  s_add_u32 s61, s61, 4096
  s_barrier
  ds_read_b64_tr_b16 v[56:57], v10 offset:0
  ds_read_b64_tr_b16 v[58:59], v10 offset:1024
  ds_read_b64_tr_b16 v[60:61], v118 offset:0
  ds_read_b64_tr_b16 v[62:63], v118 offset:1024
  s_waitcnt vmcnt(7)
  s_waitcnt lgkmcnt(2)
  v_mfma_f32_32x32x16_bf16 v[80:95], v[56:59], v[128:131], v[80:95]
  ds_read_b64_tr_b16 v[64:65], v10 offset:4096
  ds_read_b64_tr_b16 v[66:67], v10 offset:5120
  buffer_load_dwordx4 v[160:163], v2, s[24:27], s61 offen offset:0 sc1
  s_waitcnt lgkmcnt(2)
  v_mfma_f32_32x32x16_bf16 v[96:111], v[60:63], v[128:131], 0
  ds_read_b64_tr_b16 v[68:69], v118 offset:4096
  ds_read_b64_tr_b16 v[70:71], v118 offset:5120
  s_waitcnt vmcnt(7)
  s_waitcnt lgkmcnt(2)
  v_mfma_f32_32x32x16_bf16 v[80:95], v[64:67], v[132:135], v[80:95]
  ds_read_b64_tr_b16 v[56:57], v10 offset:8192
  ds_read_b64_tr_b16 v[58:59], v10 offset:9216
  buffer_load_dwordx4 v[164:167], v2, s[24:27], s61 offen offset:1024 sc1
  s_waitcnt lgkmcnt(2)
  v_mfma_f32_32x32x16_bf16 v[96:111], v[68:71], v[132:135], v[96:111]
  ds_read_b64_tr_b16 v[60:61], v118 offset:8192
  ds_read_b64_tr_b16 v[62:63], v118 offset:9216
  s_waitcnt vmcnt(7)
  s_waitcnt lgkmcnt(2)
  v_mfma_f32_32x32x16_bf16 v[80:95], v[56:59], v[136:139], v[80:95]
  ds_read_b64_tr_b16 v[64:65], v10 offset:12288
  ds_read_b64_tr_b16 v[66:67], v10 offset:13312
  buffer_load_dwordx4 v[168:171], v2, s[24:27], s61 offen offset:2048 sc1
  s_waitcnt lgkmcnt(2)
  v_mfma_f32_32x32x16_bf16 v[96:111], v[60:63], v[136:139], v[96:111]
  ds_read_b64_tr_b16 v[68:69], v118 offset:12288
  ds_read_b64_tr_b16 v[70:71], v118 offset:13312
  s_waitcnt vmcnt(7)
  s_waitcnt lgkmcnt(2)
  v_mfma_f32_32x32x16_bf16 v[80:95], v[64:67], v[140:143], v[80:95]
  ds_read_b64_tr_b16 v[56:57], v10 offset:16384
  ds_read_b64_tr_b16 v[58:59], v10 offset:17408
  buffer_load_dwordx4 v[172:175], v2, s[24:27], s61 offen offset:3072 sc1
  s_add_u32 s61, s61, 4096
  s_waitcnt lgkmcnt(2)
  v_mfma_f32_32x32x16_bf16 v[96:111], v[68:71], v[140:143], v[96:111]
  ds_read_b64_tr_b16 v[60:61], v118 offset:16384
  ds_read_b64_tr_b16 v[62:63], v118 offset:17408
  s_waitcnt vmcnt(7)
  s_waitcnt lgkmcnt(2)
  v_mfma_f32_32x32x16_bf16 v[80:95], v[56:59], v[144:147], v[80:95]
  ds_read_b64_tr_b16 v[64:65], v10 offset:20480
  ds_read_b64_tr_b16 v[66:67], v10 offset:21504
  buffer_load_dwordx4 v[176:179], v2, s[24:27], s61 offen offset:0 sc1
  s_waitcnt lgkmcnt(2)
  v_mfma_f32_32x32x16_bf16 v[96:111], v[60:63], v[144:147], v[96:111]
  ds_read_b64_tr_b16 v[68:69], v118 offset:20480
  ds_read_b64_tr_b16 v[70:71], v118 offset:21504
  s_waitcnt vmcnt(7)
  s_waitcnt lgkmcnt(2)
  v_mfma_f32_32x32x16_bf16 v[80:95], v[64:67], v[148:151], v[80:95]
  ds_read_b64_tr_b16 v[56:57], v10 offset:24576
  ds_read_b64_tr_b16 v[58:59], v10 offset:25600
  buffer_load_dwordx4 v[180:183], v2, s[24:27], s61 offen offset:1024 sc1
  s_waitcnt lgkmcnt(2)
  v_mfma_f32_32x32x16_bf16 v[96:111], v[68:71], v[148:151], v[96:111]
  ds_read_b64_tr_b16 v[60:61], v118 offset:24576
  ds_read_b64_tr_b16 v[62:63], v118 offset:25600
  s_waitcnt vmcnt(7)
  s_waitcnt lgkmcnt(2)
  v_mfma_f32_32x32x16_bf16 v[80:95], v[56:59], v[152:155], v[80:95]
  ds_read_b64_tr_b16 v[64:65], v10 offset:28672
  ds_read_b64_tr_b16 v[66:67], v10 offset:29696
  buffer_load_dwordx4 v[184:187], v2, s[24:27], s61 offen offset:2048 sc1
  s_waitcnt lgkmcnt(2)
  v_mfma_f32_32x32x16_bf16 v[96:111], v[60:63], v[152:155], v[96:111]
  ds_read_b64_tr_b16 v[68:69], v118 offset:28672
  ds_read_b64_tr_b16 v[70:71], v118 offset:29696
  s_waitcnt vmcnt(7)
  s_waitcnt lgkmcnt(2)
  v_mfma_f32_32x32x16_bf16 v[80:95], v[64:67], v[156:159], v[80:95]
  ds_read_b64_tr_b16 v[56:57], v10 offset:32768
  ds_read_b64_tr_b16 v[58:59], v10 offset:33792
  buffer_load_dwordx4 v[188:191], v2, s[24:27], s61 offen offset:3072 sc1
  s_add_u32 s61, s61, 4096
  s_waitcnt lgkmcnt(2)
  v_mfma_f32_32x32x16_bf16 v[96:111], v[68:71], v[156:159], v[96:111]
  ds_read_b64_tr_b16 v[60:61], v118 offset:32768
  ds_read_b64_tr_b16 v[62:63], v118 offset:33792
  s_waitcnt vmcnt(7)
  s_waitcnt lgkmcnt(2)
  v_mfma_f32_32x32x16_bf16 v[80:95], v[56:59], v[160:163], v[80:95]
  ds_read_b64_tr_b16 v[64:65], v10 offset:36864
  ds_read_b64_tr_b16 v[66:67], v10 offset:37888
  buffer_load_dwordx4 v[192:195], v2, s[24:27], s61 offen offset:0 sc1
  s_waitcnt lgkmcnt(2)
  v_mfma_f32_32x32x16_bf16 v[96:111], v[60:63], v[160:163], v[96:111]
  ds_read_b64_tr_b16 v[68:69], v118 offset:36864
  ds_read_b64_tr_b16 v[70:71], v118 offset:37888
  s_waitcnt vmcnt(7)
  s_waitcnt lgkmcnt(2)
  v_mfma_f32_32x32x16_bf16 v[80:95], v[64:67], v[164:167], v[80:95]
  ds_read_b64_tr_b16 v[56:57], v10 offset:40960
  ds_read_b64_tr_b16 v[58:59], v10 offset:41984
  buffer_load_dwordx4 v[196:199], v2, s[24:27], s61 offen offset:1024 sc1
  s_waitcnt lgkmcnt(2)
  v_mfma_f32_32x32x16_bf16 v[96:111], v[68:71], v[164:167], v[96:111]
  ds_read_b64_tr_b16 v[60:61], v118 offset:40960
  ds_read_b64_tr_b16 v[62:63], v118 offset:41984
  s_waitcnt vmcnt(7)
  s_waitcnt lgkmcnt(2)
  v_mfma_f32_32x32x16_bf16 v[80:95], v[56:59], v[168:171], v[80:95]
  ds_read_b64_tr_b16 v[64:65], v10 offset:45056
  ds_read_b64_tr_b16 v[66:67], v10 offset:46080
  buffer_load_dwordx4 v[200:203], v2, s[24:27], s61 offen offset:2048 sc1
  s_waitcnt lgkmcnt(2)
  v_mfma_f32_32x32x16_bf16 v[96:111], v[60:63], v[168:171], v[96:111]
  ds_read_b64_tr_b16 v[68:69], v118 offset:45056
  ds_read_b64_tr_b16 v[70:71], v118 offset:46080
  s_waitcnt vmcnt(7)
  s_waitcnt lgkmcnt(2)
  v_mfma_f32_32x32x16_bf16 v[80:95], v[64:67], v[172:175], v[80:95]
  ds_read_b64_tr_b16 v[56:57], v10 offset:49152
  ds_read_b64_tr_b16 v[58:59], v10 offset:50176
  buffer_load_dwordx4 v[204:207], v2, s[24:27], s61 offen offset:3072 sc1
  s_add_u32 s61, s61, 4096
  s_waitcnt lgkmcnt(2)
  v_mfma_f32_32x32x16_bf16 v[96:111], v[68:71], v[172:175], v[96:111]
  ds_read_b64_tr_b16 v[60:61], v118 offset:49152
  ds_read_b64_tr_b16 v[62:63], v118 offset:50176
  s_waitcnt vmcnt(7)
  s_waitcnt lgkmcnt(2)
  v_mfma_f32_32x32x16_bf16 v[80:95], v[56:59], v[176:179], v[80:95]
  ds_read_b64_tr_b16 v[64:65], v10 offset:53248
  ds_read_b64_tr_b16 v[66:67], v10 offset:54272
  buffer_load_dwordx4 v[208:211], v2, s[24:27], s61 offen offset:0 sc1
  s_waitcnt lgkmcnt(2)
  v_mfma_f32_32x32x16_bf16 v[96:111], v[60:63], v[176:179], v[96:111]
  ds_read_b64_tr_b16 v[68:69], v118 offset:53248
  ds_read_b64_tr_b16 v[70:71], v118 offset:54272
  s_waitcnt vmcnt(7)
  s_waitcnt lgkmcnt(2)
  v_mfma_f32_32x32x16_bf16 v[80:95], v[64:67], v[180:183], v[80:95]
  ds_read_b64_tr_b16 v[56:57], v10 offset:57344
  ds_read_b64_tr_b16 v[58:59], v10 offset:58368
  buffer_load_dwordx4 v[212:215], v2, s[24:27], s61 offen offset:1024 sc1
  s_waitcnt lgkmcnt(2)
  v_mfma_f32_32x32x16_bf16 v[96:111], v[68:71], v[180:183], v[96:111]
  ds_read_b64_tr_b16 v[60:61], v118 offset:57344
  ds_read_b64_tr_b16 v[62:63], v118 offset:58368
  s_barrier
  s_waitcnt vmcnt(7)
  s_waitcnt lgkmcnt(2)
  v_mfma_f32_32x32x16_bf16 v[80:95], v[56:59], v[184:187], v[80:95]
  ds_read_b64_tr_b16 v[64:65], v8 offset:0
  ds_read_b64_tr_b16 v[66:67], v8 offset:1024
  buffer_load_dwordx4 v[216:219], v2, s[24:27], s61 offen offset:2048 sc1
  s_waitcnt lgkmcnt(2)
  v_mfma_f32_32x32x16_bf16 v[96:111], v[60:63], v[184:187], v[96:111]
  ds_read_b64_tr_b16 v[68:69], v116 offset:0
  ds_read_b64_tr_b16 v[70:71], v116 offset:1024
  s_waitcnt vmcnt(7)
  s_waitcnt lgkmcnt(2)
  v_mfma_f32_32x32x16_bf16 v[80:95], v[64:67], v[188:191], v[80:95]
  ds_read_b64_tr_b16 v[56:57], v8 offset:4096
  ds_read_b64_tr_b16 v[58:59], v8 offset:5120
  buffer_load_dwordx4 v[220:223], v2, s[24:27], s61 offen offset:3072 sc1
  s_add_u32 s61, s61, 4096
  s_waitcnt lgkmcnt(2)
  v_mfma_f32_32x32x16_bf16 v[96:111], v[68:71], v[188:191], v[96:111]
  ds_read_b64_tr_b16 v[60:61], v116 offset:4096
  ds_read_b64_tr_b16 v[62:63], v116 offset:5120
  s_waitcnt vmcnt(7)
  s_waitcnt lgkmcnt(2)
  v_mfma_f32_32x32x16_bf16 v[80:95], v[56:59], v[192:195], v[80:95]
  ds_read_b64_tr_b16 v[64:65], v8 offset:8192
  ds_read_b64_tr_b16 v[66:67], v8 offset:9216
  buffer_load_dwordx4 v[128:131], v2, s[24:27], s61 offen offset:0 sc1
  s_waitcnt lgkmcnt(2)
  v_mfma_f32_32x32x16_bf16 v[96:111], v[60:63], v[192:195], v[96:111]
  ds_read_b64_tr_b16 v[68:69], v116 offset:8192
  ds_read_b64_tr_b16 v[70:71], v116 offset:9216
  s_waitcnt vmcnt(7)
  s_waitcnt lgkmcnt(2)
  v_mfma_f32_32x32x16_bf16 v[80:95], v[64:67], v[196:199], v[80:95]
  ds_read_b64_tr_b16 v[56:57], v8 offset:12288
  ds_read_b64_tr_b16 v[58:59], v8 offset:13312
  buffer_load_dwordx4 v[132:135], v2, s[24:27], s61 offen offset:1024 sc1
  s_waitcnt lgkmcnt(2)
  v_mfma_f32_32x32x16_bf16 v[96:111], v[68:71], v[196:199], v[96:111]
  ds_read_b64_tr_b16 v[60:61], v116 offset:12288
  ds_read_b64_tr_b16 v[62:63], v116 offset:13312
  s_waitcnt vmcnt(7)
  s_waitcnt lgkmcnt(2)
  v_mfma_f32_32x32x16_bf16 v[80:95], v[56:59], v[200:203], v[80:95]
  ds_read_b64_tr_b16 v[64:65], v8 offset:16384
  ds_read_b64_tr_b16 v[66:67], v8 offset:17408
  buffer_load_dwordx4 v[136:139], v2, s[24:27], s61 offen offset:2048 sc1
  s_waitcnt lgkmcnt(2)
  v_mfma_f32_32x32x16_bf16 v[96:111], v[60:63], v[200:203], v[96:111]
  ds_read_b64_tr_b16 v[68:69], v116 offset:16384
  ds_read_b64_tr_b16 v[70:71], v116 offset:17408
  s_waitcnt vmcnt(7)
  s_waitcnt lgkmcnt(2)
  v_mfma_f32_32x32x16_bf16 v[80:95], v[64:67], v[204:207], v[80:95]
  ds_read_b64_tr_b16 v[56:57], v8 offset:20480
  ds_read_b64_tr_b16 v[58:59], v8 offset:21504
  buffer_load_dwordx4 v[140:143], v2, s[24:27], s61 offen offset:3072 sc1
  s_add_u32 s61, s61, 4096
  s_waitcnt lgkmcnt(2)
  v_mfma_f32_32x32x16_bf16 v[96:111], v[68:71], v[204:207], v[96:111]
  ds_read_b64_tr_b16 v[60:61], v116 offset:20480
  ds_read_b64_tr_b16 v[62:63], v116 offset:21504
  s_waitcnt vmcnt(7)
  s_waitcnt lgkmcnt(2)
  v_mfma_f32_32x32x16_bf16 v[80:95], v[56:59], v[208:211], v[80:95]
  ds_read_b64_tr_b16 v[64:65], v8 offset:24576
  ds_read_b64_tr_b16 v[66:67], v8 offset:25600
  buffer_load_dwordx4 v[144:147], v2, s[24:27], s61 offen offset:0 sc1
  s_waitcnt lgkmcnt(2)
  v_mfma_f32_32x32x16_bf16 v[96:111], v[60:63], v[208:211], v[96:111]
  ds_read_b64_tr_b16 v[68:69], v116 offset:24576
  ds_read_b64_tr_b16 v[70:71], v116 offset:25600
  s_waitcnt vmcnt(7)
  s_waitcnt lgkmcnt(2)
  v_mfma_f32_32x32x16_bf16 v[80:95], v[64:67], v[212:215], v[80:95]
  ds_read_b64_tr_b16 v[56:57], v8 offset:28672
  ds_read_b64_tr_b16 v[58:59], v8 offset:29696
  buffer_load_dwordx4 v[148:151], v2, s[24:27], s61 offen offset:1024 sc1
  s_waitcnt lgkmcnt(2)
  v_mfma_f32_32x32x16_bf16 v[96:111], v[68:71], v[212:215], v[96:111]
  ds_read_b64_tr_b16 v[60:61], v116 offset:28672
  ds_read_b64_tr_b16 v[62:63], v116 offset:29696
  s_waitcnt vmcnt(7)
  s_waitcnt lgkmcnt(2)
  v_mfma_f32_32x32x16_bf16 v[80:95], v[56:59], v[216:219], v[80:95]
  ds_read_b64_tr_b16 v[64:65], v8 offset:32768
  ds_read_b64_tr_b16 v[66:67], v8 offset:33792
  buffer_load_dwordx4 v[152:155], v2, s[24:27], s61 offen offset:2048 sc1
  s_waitcnt lgkmcnt(2)
  v_mfma_f32_32x32x16_bf16 v[96:111], v[60:63], v[216:219], v[96:111]
  ds_read_b64_tr_b16 v[68:69], v116 offset:32768
  ds_read_b64_tr_b16 v[70:71], v116 offset:33792
  s_waitcnt vmcnt(7)
  s_waitcnt lgkmcnt(2)
  v_mfma_f32_32x32x16_bf16 v[80:95], v[64:67], v[220:223], v[80:95]
  ds_read_b64_tr_b16 v[56:57], v8 offset:36864
  ds_read_b64_tr_b16 v[58:59], v8 offset:37888
  buffer_load_dwordx4 v[156:159], v2, s[24:27], s61 offen offset:3072 sc1
  s_add_u32 s61, s61, 4096
  s_waitcnt lgkmcnt(2)
  v_mfma_f32_32x32x16_bf16 v[96:111], v[68:71], v[220:223], v[96:111]
  ds_read_b64_tr_b16 v[60:61], v116 offset:36864
  ds_read_b64_tr_b16 v[62:63], v116 offset:37888
  s_waitcnt vmcnt(7)
  s_waitcnt lgkmcnt(2)
  v_mfma_f32_32x32x16_bf16 v[80:95], v[56:59], v[128:131], v[80:95]
  ds_read_b64_tr_b16 v[64:65], v8 offset:40960
  ds_read_b64_tr_b16 v[66:67], v8 offset:41984
  buffer_load_dwordx4 v[160:163], v2, s[24:27], s61 offen offset:0 sc1
  s_waitcnt lgkmcnt(2)
  v_mfma_f32_32x32x16_bf16 v[96:111], v[60:63], v[128:131], v[96:111]
  ds_read_b64_tr_b16 v[68:69], v116 offset:40960
  ds_read_b64_tr_b16 v[70:71], v116 offset:41984
  s_waitcnt vmcnt(7)
  s_waitcnt lgkmcnt(2)
  v_mfma_f32_32x32x16_bf16 v[80:95], v[64:67], v[132:135], v[80:95]
  ds_read_b64_tr_b16 v[56:57], v8 offset:45056
  ds_read_b64_tr_b16 v[58:59], v8 offset:46080
  buffer_load_dwordx4 v[164:167], v2, s[24:27], s61 offen offset:1024 sc1
  s_waitcnt lgkmcnt(2)
  v_mfma_f32_32x32x16_bf16 v[96:111], v[68:71], v[132:135], v[96:111]
  ds_read_b64_tr_b16 v[60:61], v116 offset:45056
  ds_read_b64_tr_b16 v[62:63], v116 offset:46080
  s_waitcnt vmcnt(7)
  s_waitcnt lgkmcnt(2)
  v_mfma_f32_32x32x16_bf16 v[80:95], v[56:59], v[136:139], v[80:95]
  ds_read_b64_tr_b16 v[64:65], v8 offset:49152
  ds_read_b64_tr_b16 v[66:67], v8 offset:50176
  buffer_load_dwordx4 v[168:171], v2, s[24:27], s61 offen offset:2048 sc1
  s_waitcnt lgkmcnt(2)
  v_mfma_f32_32x32x16_bf16 v[96:111], v[60:63], v[136:139], v[96:111]
  ds_read_b64_tr_b16 v[68:69], v116 offset:49152
  ds_read_b64_tr_b16 v[70:71], v116 offset:50176
  s_waitcnt vmcnt(7)
  s_waitcnt lgkmcnt(2)
  v_mfma_f32_32x32x16_bf16 v[80:95], v[64:67], v[140:143], v[80:95]
  ds_read_b64_tr_b16 v[56:57], v8 offset:53248
  ds_read_b64_tr_b16 v[58:59], v8 offset:54272
  buffer_load_dwordx4 v[172:175], v2, s[24:27], s61 offen offset:3072 sc1
  s_add_u32 s61, s61, 4096
  s_waitcnt lgkmcnt(2)
  v_mfma_f32_32x32x16_bf16 v[96:111], v[68:71], v[140:143], v[96:111]
  ds_read_b64_tr_b16 v[60:61], v116 offset:53248
  ds_read_b64_tr_b16 v[62:63], v116 offset:54272
  s_waitcnt vmcnt(7)
  s_waitcnt lgkmcnt(2)
  v_mfma_f32_32x32x16_bf16 v[80:95], v[56:59], v[144:147], v[80:95]
  ds_read_b64_tr_b16 v[64:65], v8 offset:57344
  ds_read_b64_tr_b16 v[66:67], v8 offset:58368
  buffer_load_dwordx4 v[176:179], v2, s[24:27], s61 offen offset:0 sc1
  s_waitcnt lgkmcnt(2)
  v_mfma_f32_32x32x16_bf16 v[96:111], v[60:63], v[144:147], v[96:111]
  ds_read_b64_tr_b16 v[68:69], v116 offset:57344
  ds_read_b64_tr_b16 v[70:71], v116 offset:58368
  s_waitcnt vmcnt(7)
  s_waitcnt lgkmcnt(2)
  v_mfma_f32_32x32x16_bf16 v[80:95], v[64:67], v[148:151], v[80:95]
  ds_read_b64_tr_b16 v[56:57], v8 offset:61440
  ds_read_b64_tr_b16 v[58:59], v8 offset:62464
  buffer_load_dwordx4 v[180:183], v2, s[24:27], s61 offen offset:1024 sc1
  s_waitcnt lgkmcnt(2)
  v_mfma_f32_32x32x16_bf16 v[96:111], v[68:71], v[148:151], v[96:111]
  ds_read_b64_tr_b16 v[60:61], v116 offset:61440
  ds_read_b64_tr_b16 v[62:63], v116 offset:62464
  s_waitcnt vmcnt(7)
  s_waitcnt lgkmcnt(2)
  v_mfma_f32_32x32x16_bf16 v[80:95], v[56:59], v[152:155], v[80:95]
  ds_read_b64_tr_b16 v[64:65], v9 offset:0
  ds_read_b64_tr_b16 v[66:67], v9 offset:1024
  buffer_load_dwordx4 v[184:187], v2, s[24:27], s61 offen offset:2048 sc1
  s_waitcnt lgkmcnt(2)
  v_mfma_f32_32x32x16_bf16 v[96:111], v[60:63], v[152:155], v[96:111]
  ds_read_b64_tr_b16 v[68:69], v117 offset:0
  ds_read_b64_tr_b16 v[70:71], v117 offset:1024
  s_waitcnt vmcnt(7)
  s_waitcnt lgkmcnt(2)
  v_mfma_f32_32x32x16_bf16 v[80:95], v[64:67], v[156:159], v[80:95]
  ds_read_b64_tr_b16 v[56:57], v9 offset:4096
  ds_read_b64_tr_b16 v[58:59], v9 offset:5120
  buffer_load_dwordx4 v[188:191], v2, s[24:27], s61 offen offset:3072 sc1
  s_add_u32 s61, s61, 4096
  s_waitcnt lgkmcnt(2)
  v_mfma_f32_32x32x16_bf16 v[96:111], v[68:71], v[156:159], v[96:111]
  ds_read_b64_tr_b16 v[60:61], v117 offset:4096
  ds_read_b64_tr_b16 v[62:63], v117 offset:5120
  s_barrier
  s_waitcnt vmcnt(7)
  s_waitcnt lgkmcnt(2)
  v_mfma_f32_32x32x16_bf16 v[80:95], v[56:59], v[160:163], v[80:95]
  ds_read_b64_tr_b16 v[64:65], v9 offset:8192
  ds_read_b64_tr_b16 v[66:67], v9 offset:9216
  buffer_load_dwordx4 v[192:195], v2, s[24:27], s61 offen offset:0 sc1
  s_waitcnt lgkmcnt(2)
  v_mfma_f32_32x32x16_bf16 v[96:111], v[60:63], v[160:163], v[96:111]
  ds_read_b64_tr_b16 v[68:69], v117 offset:8192
  ds_read_b64_tr_b16 v[70:71], v117 offset:9216
  s_waitcnt vmcnt(7)
  s_waitcnt lgkmcnt(2)
  v_mfma_f32_32x32x16_bf16 v[80:95], v[64:67], v[164:167], v[80:95]
  ds_read_b64_tr_b16 v[56:57], v9 offset:12288
  ds_read_b64_tr_b16 v[58:59], v9 offset:13312
  buffer_load_dwordx4 v[196:199], v2, s[24:27], s61 offen offset:1024 sc1
  s_waitcnt lgkmcnt(2)
  v_mfma_f32_32x32x16_bf16 v[96:111], v[68:71], v[164:167], v[96:111]
  ds_read_b64_tr_b16 v[60:61], v117 offset:12288
  ds_read_b64_tr_b16 v[62:63], v117 offset:13312
  s_waitcnt vmcnt(7)
  s_waitcnt lgkmcnt(2)
  v_mfma_f32_32x32x16_bf16 v[80:95], v[56:59], v[168:171], v[80:95]
  ds_read_b64_tr_b16 v[64:65], v9 offset:16384
  ds_read_b64_tr_b16 v[66:67], v9 offset:17408
  buffer_load_dwordx4 v[200:203], v2, s[24:27], s61 offen offset:2048 sc1
  s_waitcnt lgkmcnt(2)
  v_mfma_f32_32x32x16_bf16 v[96:111], v[60:63], v[168:171], v[96:111]
  ds_read_b64_tr_b16 v[68:69], v117 offset:16384
  ds_read_b64_tr_b16 v[70:71], v117 offset:17408
  s_waitcnt vmcnt(7)
  s_waitcnt lgkmcnt(2)
  v_mfma_f32_32x32x16_bf16 v[80:95], v[64:67], v[172:175], v[80:95]
  ds_read_b64_tr_b16 v[56:57], v9 offset:20480
  ds_read_b64_tr_b16 v[58:59], v9 offset:21504
  s_waitcnt lgkmcnt(2)
  v_mfma_f32_32x32x16_bf16 v[96:111], v[68:71], v[172:175], v[96:111]
  ds_read_b64_tr_b16 v[60:61], v117 offset:20480
  ds_read_b64_tr_b16 v[62:63], v117 offset:21504
  s_waitcnt vmcnt(6)
  s_waitcnt lgkmcnt(2)
  v_mfma_f32_32x32x16_bf16 v[80:95], v[56:59], v[176:179], v[80:95]
  ds_read_b64_tr_b16 v[64:65], v9 offset:24576
  ds_read_b64_tr_b16 v[66:67], v9 offset:25600
  s_waitcnt lgkmcnt(2)
  v_mfma_f32_32x32x16_bf16 v[96:111], v[60:63], v[176:179], v[96:111]
  ds_read_b64_tr_b16 v[68:69], v117 offset:24576
  ds_read_b64_tr_b16 v[70:71], v117 offset:25600
  s_waitcnt vmcnt(5)
  s_waitcnt lgkmcnt(2)
  v_mfma_f32_32x32x16_bf16 v[80:95], v[64:67], v[180:183], v[80:95]
  ds_read_b64_tr_b16 v[56:57], v9 offset:28672
  ds_read_b64_tr_b16 v[58:59], v9 offset:29696
  s_waitcnt lgkmcnt(2)
  v_mfma_f32_32x32x16_bf16 v[96:111], v[68:71], v[180:183], v[96:111]
  ds_read_b64_tr_b16 v[60:61], v117 offset:28672
  ds_read_b64_tr_b16 v[62:63], v117 offset:29696
  s_waitcnt vmcnt(4)
  s_waitcnt lgkmcnt(2)
  v_mfma_f32_32x32x16_bf16 v[80:95], v[56:59], v[184:187], v[80:95]
  ds_read_b64_tr_b16 v[64:65], v10 offset:0
  ds_read_b64_tr_b16 v[66:67], v10 offset:1024
  s_waitcnt lgkmcnt(2)
  v_mfma_f32_32x32x16_bf16 v[96:111], v[60:63], v[184:187], v[96:111]
  ds_read_b64_tr_b16 v[68:69], v118 offset:0
  ds_read_b64_tr_b16 v[70:71], v118 offset:1024
  s_waitcnt vmcnt(3)
  s_waitcnt lgkmcnt(2)
  v_mfma_f32_32x32x16_bf16 v[80:95], v[64:67], v[188:191], v[80:95]
  ds_read_b64_tr_b16 v[56:57], v10 offset:4096
  ds_read_b64_tr_b16 v[58:59], v10 offset:5120
  s_waitcnt lgkmcnt(2)
  v_mfma_f32_32x32x16_bf16 v[96:111], v[68:71], v[188:191], v[96:111]
  ds_read_b64_tr_b16 v[60:61], v118 offset:4096
  ds_read_b64_tr_b16 v[62:63], v118 offset:5120
  s_waitcnt vmcnt(2)
  s_waitcnt lgkmcnt(2)
  v_mfma_f32_32x32x16_bf16 v[80:95], v[56:59], v[192:195], v[80:95]
  ds_read_b64_tr_b16 v[64:65], v10 offset:8192
  ds_read_b64_tr_b16 v[66:67], v10 offset:9216
  s_waitcnt lgkmcnt(2)
  v_mfma_f32_32x32x16_bf16 v[96:111], v[60:63], v[192:195], v[96:111]
  ds_read_b64_tr_b16 v[68:69], v118 offset:8192
  ds_read_b64_tr_b16 v[70:71], v118 offset:9216
  s_waitcnt vmcnt(1)
  s_waitcnt lgkmcnt(2)
  v_mfma_f32_32x32x16_bf16 v[80:95], v[64:67], v[196:199], v[80:95]
  ds_read_b64_tr_b16 v[56:57], v10 offset:12288
  ds_read_b64_tr_b16 v[58:59], v10 offset:13312
  s_waitcnt lgkmcnt(2)
  v_mfma_f32_32x32x16_bf16 v[96:111], v[68:71], v[196:199], v[96:111]
  ds_read_b64_tr_b16 v[60:61], v118 offset:12288
  ds_read_b64_tr_b16 v[62:63], v118 offset:13312
  s_waitcnt vmcnt(0)
  s_waitcnt lgkmcnt(2)
  v_mfma_f32_32x32x16_bf16 v[80:95], v[56:59], v[200:203], v[80:95]
  s_waitcnt lgkmcnt(0)
  v_mfma_f32_32x32x16_bf16 v[96:111], v[60:63], v[200:203], v[96:111]
  s_nop 11
  ds_write_b128 v114, v[96:99] offset:0
  ds_write_b128 v114, v[100:103] offset:1024
  ds_write_b128 v114, v[104:107] offset:2048
  ds_write_b128 v114, v[108:111] offset:3072
  s_waitcnt lgkmcnt(0)
  s_barrier
  ds_read_b128 v[32:35], v115 offset:0
  ds_read_b128 v[36:39], v115 offset:1024
  ds_read_b128 v[40:43], v115 offset:2048
  ds_read_b128 v[44:47], v115 offset:3072
  s_waitcnt lgkmcnt(3)
  v_pk_add_f32 v[80:81], v[80:81], v[32:33]
  v_pk_mul_f32 v[80:81], v[80:81], s[6:7]
  v_pk_add_f32 v[82:83], v[82:83], v[34:35]
  v_pk_mul_f32 v[82:83], v[82:83], s[6:7]
  s_waitcnt lgkmcnt(2)
  v_pk_add_f32 v[84:85], v[84:85], v[36:37]
  v_pk_mul_f32 v[84:85], v[84:85], s[6:7]
  v_pk_add_f32 v[86:87], v[86:87], v[38:39]
  v_pk_mul_f32 v[86:87], v[86:87], s[6:7]
  s_waitcnt lgkmcnt(1)
  v_pk_add_f32 v[88:89], v[88:89], v[40:41]
  v_pk_mul_f32 v[88:89], v[88:89], s[6:7]
  v_pk_add_f32 v[90:91], v[90:91], v[42:43]
  v_pk_mul_f32 v[90:91], v[90:91], s[6:7]
  s_waitcnt lgkmcnt(0)
  v_pk_add_f32 v[92:93], v[92:93], v[44:45]
  v_pk_mul_f32 v[92:93], v[92:93], s[6:7]
  v_pk_add_f32 v[94:95], v[94:95], v[46:47]
  v_pk_mul_f32 v[94:95], v[94:95], s[6:7]
  v_cvt_pk_bf16_f32 v72, v80, v81
  v_cvt_pk_bf16_f32 v73, v82, v83
  v_cvt_pk_bf16_f32 v74, v84, v85
  v_cvt_pk_bf16_f32 v75, v86, v87
  v_cvt_pk_bf16_f32 v76, v88, v89
  v_cvt_pk_bf16_f32 v77, v90, v91
  v_cvt_pk_bf16_f32 v78, v92, v93
  v_cvt_pk_bf16_f32 v79, v94, v95
  s_cmp_eq_u32 s47, 1
  s_cbranch_scc1 Lfin_94
  s_cmp_eq_u32 s45, 0
  s_cbranch_scc1 Lgs_96
  buffer_store_dwordx4 v[72:75], v2, s[24:27], s66 offen
  buffer_store_dwordx4 v[76:79], v2, s[24:27], s66 offen offset:1024
  s_branch Lgsd_97
Lgs_96:
  buffer_store_dwordx4 v[72:75], v2, s[24:27], s66 offen sc1
  buffer_store_dwordx4 v[76:79], v2, s[24:27], s66 offen offset:1024 sc1
Lgsd_97:
  v_pk_mul_f32 v[10:11], v[80:81], v[80:81]
  v_pk_add_f32 v[8:9], v[80:81], v[82:83]
  v_pk_fma_f32 v[10:11], v[82:83], v[82:83], v[10:11]
  v_pk_add_f32 v[8:9], v[8:9], v[84:85]
  v_pk_fma_f32 v[10:11], v[84:85], v[84:85], v[10:11]
  v_pk_add_f32 v[8:9], v[8:9], v[86:87]
  v_pk_fma_f32 v[10:11], v[86:87], v[86:87], v[10:11]
  v_pk_add_f32 v[8:9], v[8:9], v[88:89]
  v_pk_fma_f32 v[10:11], v[88:89], v[88:89], v[10:11]
  v_pk_add_f32 v[8:9], v[8:9], v[90:91]
  v_pk_fma_f32 v[10:11], v[90:91], v[90:91], v[10:11]
  v_pk_add_f32 v[8:9], v[8:9], v[92:93]
  v_pk_fma_f32 v[10:11], v[92:93], v[92:93], v[10:11]
  v_pk_add_f32 v[8:9], v[8:9], v[94:95]
  v_pk_fma_f32 v[10:11], v[94:95], v[94:95], v[10:11]
  v_add_f32 v8, v8, v9
  v_add_f32 v10, v10, v11
  s_nop 1
  v_permlane32_swap_b32 v8, v10
  v_add_f32 v8, v8, v10
  s_cmp_eq_u32 s45, 0
  s_cbranch_scc1 Lgs_98
  buffer_store_dword v8, v2, s[24:27], s67 offen
  s_branch Lgsd_99
Lgs_98:
  buffer_store_dword v8, v2, s[24:27], s67 offen sc1
Lgsd_99:
  s_waitcnt vmcnt(0)
  s_mov_b64 exec, 1
  v_mov_b32 v14, s43
  v_mov_b32 v15, 0
  s_cmp_eq_u32 s45, 0
  s_cbranch_scc1 Lgs_100
  buffer_store_dword v14, v15, s[24:27], s68 offen
  s_branch Lgsd_101
Lgs_100:
  buffer_store_dword v14, v15, s[24:27], s68 offen sc1
Lgsd_101:
  s_mov_b64 exec, -1
  s_branch Lfind_95
Lfin_94:
  v_permlane32_swap_b32 v72, v74
  v_permlane32_swap_b32 v73, v75
  v_permlane32_swap_b32 v76, v78
  v_permlane32_swap_b32 v77, v79
  v_and_b32 v12, 31, v1
  v_lshl_add_u32 v12, v12, 10, v5
  s_lshl_b32 s66, s82, 15
  s_lshl_b32 s83, s52, 6
  s_add_u32 s66, s66, s83
  buffer_store_dwordx4 v[72:75], v12, s[28:31], s66 offen
  buffer_store_dwordx4 v[76:79], v12, s[28:31], s66 offen offset:32
  s_waitcnt vmcnt(0)
Lfind_95:
  s_barrier
  s_branch L_mlp2_d
L_mlp2_h:
  s_waitcnt vmcnt(0)
  s_barrier
  v_lshrrev_b32 v14, 3, v1
  v_mul_u32_u24 v14, 1024, v14
  v_bfe_u32 v15, v1, 4, 1
  v_lshlrev_b32 v15, 2, v15
  v_xor_b32 v15, v15, v1
  v_and_b32 v15, 7, v15
  v_lshl_add_u32 v8, v15, 4, v14
  s_sub_u32 s50, s42, 4
  s_lshr_b32 s51, s50, 1
  s_mul_i32 s51, s51, 43
  s_add_u32 s51, s51, 39
  s_and_b32 s52, s50, 1
  s_and_b32 s53, s41, 7
  s_lshl_b32 s51, s51, 14
  s_lshl_b32 s83, s52, 13
  s_add_u32 s51, s51, s83
  s_lshl_b32 s83, s53, 7
  s_add_u32 s51, s51, s83
  s_lshl_b32 s52, s50, 10
  s_add_u32 s52, s52, 98304
  s_lshr_b32 s53, s41, 3
  s_mul_i32 s53, s53, 4
  s_lshr_b32 s53, s53, 2
  s_mov_b32 s73, s53
  s_mul_i32 s74, s73, 16384
  s_mul_i32 s75, s73, 4096
  s_add_u32 s74, s74, s51
  s_add_u32 s75, s75, s52
  s_mov_b32 m0, s75
  s_add_u32 s73, s73, 1
  buffer_load_dwordx4 v8, s[20:23], s74 offen lds
  s_cmp_eq_u32 s73, 4
  s_cselect_b32 s73, 0, s73
  s_mul_i32 s74, s73, 16384
  s_mul_i32 s75, s73, 4096
  s_add_u32 s74, s74, s51
  s_add_u32 s75, s75, s52
  s_mov_b32 m0, s75
  s_add_u32 s73, s73, 1
  buffer_load_dwordx4 v8, s[20:23], s74 offen lds
  s_cmp_eq_u32 s73, 4
  s_cselect_b32 s73, 0, s73
  s_mul_i32 s74, s73, 16384
  s_mul_i32 s75, s73, 4096
  s_add_u32 s74, s74, s51
  s_add_u32 s75, s75, s52
  s_mov_b32 m0, s75
  s_add_u32 s73, s73, 1
  buffer_load_dwordx4 v8, s[20:23], s74 offen lds
  s_cmp_eq_u32 s73, 4
  s_cselect_b32 s73, 0, s73
  s_mul_i32 s74, s73, 16384
  s_mul_i32 s75, s73, 4096
  s_add_u32 s74, s74, s51
  s_add_u32 s75, s75, s52
  s_mov_b32 m0, s75
  s_add_u32 s73, s73, 1
  buffer_load_dwordx4 v8, s[20:23], s74 offen lds
  s_waitcnt vmcnt(0)
  s_barrier
  s_barrier
  s_cmp_eq_u32 s47, 1
  s_cbranch_scc1 Lnq_102
  s_sub_u32 s74, s42, 4
  s_lshl_b32 s75, s74, 14
  s_add_u32 s75, s75, 32768
  v_add_u32 v138, s75, v2
  s_lshl_b32 s75, s74, 13
  v_add_u32 v139, s75, v2
  ds_write_b128 v138, v[144:147] offset:0
  ds_write_b128 v138, v[148:151] offset:1024
  ds_write_b128 v138, v[152:155] offset:2048
  ds_write_b128 v138, v[156:159] offset:3072
  ds_write_b128 v138, v[160:163] offset:4096
  ds_write_b128 v138, v[164:167] offset:5120
  ds_write_b128 v138, v[168:171] offset:6144
  ds_write_b128 v138, v[172:175] offset:7168
  ds_write_b128 v138, v[176:179] offset:8192
  ds_write_b128 v138, v[180:183] offset:9216
  ds_write_b128 v138, v[184:187] offset:10240
  ds_write_b128 v138, v[188:191] offset:11264
  ds_write_b128 v138, v[192:195] offset:12288
  ds_write_b128 v138, v[196:199] offset:13312
  ds_write_b128 v138, v[200:203] offset:14336
  ds_write_b128 v138, v[204:207] offset:15360
  ds_write_b128 v139, v[208:211] offset:0
  ds_write_b128 v139, v[212:215] offset:1024
  ds_write_b128 v139, v[216:219] offset:2048
  ds_write_b128 v139, v[220:223] offset:3072
  ds_write_b128 v139, v[224:227] offset:4096
  ds_write_b128 v139, v[228:231] offset:5120
  ds_write_b128 v139, v[232:235] offset:6144
  ds_write_b128 v139, v[236:239] offset:7168
  s_barrier
  v_lshrrev_b32 v14, 3, v1
  v_mul_u32_u24 v14, 1024, v14
  v_bfe_u32 v15, v1, 4, 1
  v_lshlrev_b32 v15, 2, v15
  v_xor_b32 v15, v15, v1
  v_and_b32 v15, 7, v15
  v_lshl_add_u32 v8, v15, 4, v14
  s_sub_u32 s50, s42, 4
  s_and_b32 s51, s41, 7
  s_lshl_b32 s51, s51, 7
  s_lshl_b32 s83, s50, 13
  s_add_u32 s51, s51, s83
  s_lshl_b32 s52, s50, 10
  s_add_u32 s52, s52, 98304
  s_lshr_b32 s53, s41, 3
  s_mul_i32 s53, s53, 6
  s_lshr_b32 s53, s53, 2
  s_mov_b32 s73, s53
  s_mul_i32 s74, s73, 32768
  s_mul_i32 s75, s73, 4096
  s_add_u32 s74, s74, s51
  s_add_u32 s75, s75, s52
  s_mov_b32 m0, s75
  s_add_u32 s73, s73, 1
  buffer_load_dwordx4 v8, s[12:15], s74 offen lds
  s_cmp_eq_u32 s73, 6
  s_cselect_b32 s73, 0, s73
  s_mul_i32 s74, s73, 32768
  s_mul_i32 s75, s73, 4096
  s_add_u32 s74, s74, s51
  s_add_u32 s75, s75, s52
  s_mov_b32 m0, s75
  s_add_u32 s73, s73, 1
  buffer_load_dwordx4 v8, s[12:15], s74 offen lds
  s_cmp_eq_u32 s73, 6
  s_cselect_b32 s73, 0, s73
  s_mul_i32 s74, s73, 32768
  s_mul_i32 s75, s73, 4096
  s_add_u32 s74, s74, s51
  s_add_u32 s75, s75, s52
  s_mov_b32 m0, s75
  s_add_u32 s73, s73, 1
  buffer_load_dwordx4 v8, s[12:15], s74 offen lds
  s_cmp_eq_u32 s73, 6
  s_cselect_b32 s73, 0, s73
  s_mul_i32 s74, s73, 32768
  s_mul_i32 s75, s73, 4096
  s_add_u32 s74, s74, s51
  s_add_u32 s75, s75, s52
  s_mov_b32 m0, s75
  s_add_u32 s73, s73, 1
  buffer_load_dwordx4 v8, s[12:15], s74 offen lds
  s_cmp_eq_u32 s73, 6
  s_cselect_b32 s73, 0, s73
  s_mul_i32 s74, s73, 32768
  s_mul_i32 s75, s73, 4096
  s_add_u32 s74, s74, s51
  s_add_u32 s75, s75, s52
  s_mov_b32 m0, s75
  s_add_u32 s73, s73, 1
  buffer_load_dwordx4 v8, s[12:15], s74 offen lds
  s_cmp_eq_u32 s73, 6
  s_cselect_b32 s73, 0, s73
  s_mul_i32 s74, s73, 32768
  s_mul_i32 s75, s73, 4096
  s_add_u32 s74, s74, s51
  s_add_u32 s75, s75, s52
  s_mov_b32 m0, s75
  s_add_u32 s73, s73, 1
  buffer_load_dwordx4 v8, s[12:15], s74 offen lds
  s_branch Lnq2_103
Lnq_102:
  s_barrier
Lnq2_103:
L_mlp2_d:
  s_add_u32 s47, s47, 1
  s_add_u32 s46, s46, 4718592
  s_cmp_lt_u32 s47, 2
  s_cbranch_scc0 L_fin
  s_branch L_layer
L_fin:
L_exit:
  s_endpgm

.section .rodata,"a"
.p2align 6
.amdhsa_kernel interleave_layers__sliding_block__mixer_channel_mlp__prompt_kernel
  .amdhsa_next_free_vgpr 256
  .amdhsa_next_free_sgpr 102
  .amdhsa_accum_offset 256
  .amdhsa_group_segment_fixed_size 0
  .amdhsa_kernarg_size 88
  .amdhsa_user_sgpr_count 2
  .amdhsa_user_sgpr_kernarg_segment_ptr 1
  .amdhsa_system_sgpr_workgroup_id_x 1
.end_amdhsa_kernel
```
